```python
import torch

def _softmax(x, axis=-1):
    return torch.softmax(x, dim=axis)
def _gelu(x):
    return torch.nn.functional.gelu(x, approximate="tanh")
def _silu(x):
    return torch.nn.functional.silu(x)
def _sigmoid(x):
    return torch.sigmoid(x)
def _layernorm(x, axis=-1, eps=1e-5):
    m = x.mean(dim=axis, keepdim=True)
    v = x.var(dim=axis, keepdim=True, unbiased=False)
    return (x - m) / torch.sqrt(v + eps)
def _scatter_add(tgt, idx, src, axis=0):
    return tgt.clone().index_add_(axis, idx, src)
def _segment_sum(src, seg, n):
    out = torch.zeros((n,) + src.shape[1:], dtype=src.dtype)
    return out.index_add_(0, seg, src)
def _pad(x, pw):
    flat = tuple(v for pair in reversed(pw) for v in pair)
    return torch.nn.functional.pad(x, flat)

kernel_name = 'parallel_sum__mha_block__glu_gated_bilinear__prompt'

def setup_inputs():

    _w = (lambda a: (lambda t: t.to(torch.bfloat16) if t.is_floating_point() else t)(torch.as_tensor(a)))
    def _A_setup():
        B, S, D, H = 1, 2048, 640, 32
        return {
            "x": _w((lambda *s: torch.randn(*s, dtype=torch.bfloat16) * 0.05)(B, S, D)),
            "wqkv": _w((lambda *s: torch.randn(*s, dtype=torch.bfloat16) * 0.05)(D, 3 * D)),
            "wo": _w((lambda *s: torch.randn(*s, dtype=torch.bfloat16) * 0.05)(D, D)),
        }
    _A_in = _A_setup()

    def _B_setup():
        B, S, D, F = 1, 2048, 640, 1728
        return {
            "x": _w((lambda *s: torch.randn(*s, dtype=torch.bfloat16) * 0.05)(B, S, D)),
            "w_gate": _w((lambda *s: torch.randn(*s, dtype=torch.bfloat16) * 0.8)(D, F) * (D ** -0.5)),
            "w_up": _w((lambda *s: torch.randn(*s, dtype=torch.bfloat16) * 0.8)(D, F) * (D ** -0.5)),
            "w_down": _w((lambda *s: torch.randn(*s, dtype=torch.bfloat16) * 0.8)(F, D) * (F ** -0.5)),
        }
    _B_in = _B_setup()

    return {
        "A_x": _A_in["x"],
        "A_wqkv": _A_in["wqkv"],
        "A_wo": _A_in["wo"],
        "B_x": _B_in["x"],
        "B_w_gate": _B_in["w_gate"],
        "B_w_up": _B_in["w_up"],
        "B_w_down": _B_in["w_down"],
    }

def reference(A_x, A_wqkv, A_wo, B_x, B_w_gate, B_w_up, B_w_down):
    def _A_ref(x, wqkv, wo):
        B, S, D = x.shape
        H = 32
        Dh = D // H
        qkv = (lambda x, *d: x.permute(*d))((x @ wqkv).reshape(B, S, 3, H, Dh), 2, 0, 3, 1, 4)
        q, k, v = qkv[0], qkv[1], qkv[2]
        scores = torch.einsum("bhqd,bhkd->bhqk", q, k) * (Dh ** -0.5)
        p = _softmax(scores, axis=-1)
        o = torch.einsum("bhqk,bhkd->bhqd", p, v)
        return (lambda x, *d: x.permute(*d))(o, 0, 2, 1, 3).reshape(B, S, D) @ wo

    def _B_ref(x, w_gate, w_up, w_down):
        g = torch.einsum("bsd,df->bsf", x, w_gate)
        u = torch.einsum("bsd,df->bsf", x, w_up)
        h = g * u
        return torch.einsum("bsf,fd->bsd", h, w_down)

    x = A_x
    xn = _layernorm(x, axis=-1)
    return x + _A_ref(xn, A_wqkv, A_wo) + _B_ref(xn, B_w_gate, B_w_up, B_w_down)
```

```asm
; @launch kernel=mha_k1_kernel grid=(256,1,1) block=(512,1,1) lds=147456
; @launch kernel=mha_k2_kernel grid=(256,1,1) block=(256,1,1) lds=108544
.amdgcn_target "amdgcn-amd-amdhsa--gfx950"
.text
.globl mha_k1_kernel
.p2align 8
.type mha_k1_kernel,@function
mha_k1_kernel:
    s_cmp_ge_u32 s2, 256
    s_cbranch_scc1 K1_END
    s_load_dwordx4 s[4:7], s[0:1], 0
    s_load_dwordx2 s[8:9], s[0:1], 16
    s_load_dwordx4 s[12:15], s[0:1], 40
    s_load_dwordx2 s[10:11], s[0:1], 32
    s_load_dwordx2 s[16:17], s[0:1], 72
    v_lshrrev_b32 v1, 6, v0
    s_and_b32 s54, s2, 7
    s_lshr_b32 s55, s2, 3
    v_readfirstlane_b32 s38, v1
    s_and_b32 s36, s54, 1
    s_lshl_b32 s36, s36, 3
    s_and_b32 s69, s55, 7
    s_add_u32 s36, s36, s69
    s_lshr_b32 s37, s54, 1
    s_lshl_b32 s37, s37, 2
    s_lshr_b32 s65, s55, 3
    s_add_u32 s37, s37, s65
    v_and_b32 v0, 63, v0
    v_lshrrev_b32 v8, 3, v0
    s_lshl_b32 s55, s38, 4
    v_add_u32 v8, s55, v8
    v_and_b32 v10, 7, v0
    v_mul_u32_u24 v11, 1280, v8
    v_lshl_add_u32 v4, v10, 4, v11
    v_add_u32 v5, 10240, v4
    s_mul_i32 s60, s36, 163840
    s_cmp_eq_u32 s37, 15
    s_waitcnt lgkmcnt(0)
    s_cbranch_scc1 K1_AUX
    s_mov_b32 s28, s4
    s_mov_b32 s29, s5
    s_mov_b32 s30, 0x280000
    s_mov_b32 s31, 0x00020000
    buffer_load_dwordx4 v[176:179], v4, s[28:31], s60 offen offset:0
    buffer_load_dwordx4 v[180:183], v5, s[28:31], s60 offen offset:0
    buffer_load_dwordx4 v[184:187], v4, s[28:31], s60 offen offset:128
    buffer_load_dwordx4 v[188:191], v5, s[28:31], s60 offen offset:128
    buffer_load_dwordx4 v[192:195], v4, s[28:31], s60 offen offset:256
    buffer_load_dwordx4 v[196:199], v5, s[28:31], s60 offen offset:256
    buffer_load_dwordx4 v[200:203], v4, s[28:31], s60 offen offset:384
    buffer_load_dwordx4 v[204:207], v5, s[28:31], s60 offen offset:384
    buffer_load_dwordx4 v[208:211], v4, s[28:31], s60 offen offset:512
    buffer_load_dwordx4 v[212:215], v5, s[28:31], s60 offen offset:512
    buffer_load_dwordx4 v[216:219], v4, s[28:31], s60 offen offset:640
    buffer_load_dwordx4 v[220:223], v5, s[28:31], s60 offen offset:640
    buffer_load_dwordx4 v[224:227], v4, s[28:31], s60 offen offset:768
    buffer_load_dwordx4 v[228:231], v5, s[28:31], s60 offen offset:768
    buffer_load_dwordx4 v[232:235], v4, s[28:31], s60 offen offset:896
    buffer_load_dwordx4 v[236:239], v5, s[28:31], s60 offen offset:896
    buffer_load_dwordx4 v[240:243], v4, s[28:31], s60 offen offset:1024
    buffer_load_dwordx4 v[244:247], v5, s[28:31], s60 offen offset:1024
    buffer_load_dwordx4 v[248:251], v4, s[28:31], s60 offen offset:1152
    buffer_load_dwordx4 v[252:255], v5, s[28:31], s60 offen offset:1152
    v_lshrrev_b32 v6, 4, v0
    v_xor_b32 v11, v6, v10
    v_lshlrev_b32 v8, 7, v8
    v_add_u32 v8, 98304, v8
    v_lshl_add_u32 v74, v11, 4, v8
    v_xor_b32 v11, 4, v11
    v_lshl_add_u32 v75, v11, 4, v8
    v_add_u32 v75, 1024, v75
    s_lshr_b32 s40, s38, 2
    s_and_b32 s39, s38, 3
    s_mov_b32 s52, 0xffff0000
    v_bfe_u32 v7, v0, 2, 2
    v_and_b32 v9, 3, v0
    v_lshlrev_b32 v9, 4, v9
    s_and_b32 s56, s38, 1
    s_lshr_b32 s57, s38, 1
    s_mul_i32 s59, s56, 12288
    s_mul_i32 s55, s57, 3072
    s_add_u32 s59, s59, s55
    s_add_u32 s66, s59, 98304
    s_lshl_b32 s55, s57, 3
    v_add_u32 v7, s55, v7
    s_mov_b32 s47, s59
    s_cmp_lt_u32 s37, 6
    s_cbranch_scc0 K1_SETGU
    s_mov_b32 s20, s6
    s_mov_b32 s21, s7
    s_mov_b32 s22, 0x258000
    s_mov_b32 s23, 0x00020000
    s_movk_i32 s54, 3840
    s_mul_i32 s58, s37, 640
    s_mul_i32 s55, s56, 320
    s_add_u32 s58, s58, s55
    s_mov_b32 s55, 5
    s_branch K1_SET2
K1_SETGU:
    s_cmp_eq_u32 s56, 0
    s_cselect_b32 s20, s10, s12
    s_cselect_b32 s21, s11, s13
    s_mov_b32 s22, 0x21c000
    s_mov_b32 s23, 0x00020000
    s_movk_i32 s54, 3456
    s_sub_u32 s58, s37, 6
    s_mul_i32 s58, s58, 384
    s_mov_b32 s55, 6
K1_SET2:
    s_lshl_b32 s44, s54, 5
    s_mul_i32 s53, s44, 19
    s_add_u32 s53, s53, s58
    s_mov_b32 s41, s58
    v_bfrev_b32 v10, 1
    v_add_u32 v8, 0, v6
    v_cmp_le_u32 vcc, 6, v8
    s_nop 1
    v_cndmask_b32 v11, 0, 1, vcc
    v_mul_u32_u24 v12, 6, v11
    v_sub_u32 v8, v8, v12
    v_lshl_add_u32 v11, v11, 2, v7
    v_mul_lo_u32 v11, v11, s54
    v_lshl_add_u32 v12, v8, 6, v9
    v_add_u32 v11, v11, v12
    v_cmp_gt_u32 vcc, s55, v8
    s_nop 1
    v_cndmask_b32 v1, v10, v11, vcc
    v_add_u32 v8, 4, v6
    v_cmp_le_u32 vcc, 6, v8
    s_nop 1
    v_cndmask_b32 v11, 0, 1, vcc
    v_mul_u32_u24 v12, 6, v11
    v_sub_u32 v8, v8, v12
    v_lshl_add_u32 v11, v11, 2, v7
    v_mul_lo_u32 v11, v11, s54
    v_lshl_add_u32 v12, v8, 6, v9
    v_add_u32 v11, v11, v12
    v_cmp_gt_u32 vcc, s55, v8
    s_nop 1
    v_cndmask_b32 v2, v10, v11, vcc
    v_add_u32 v8, 8, v6
    v_cmp_le_u32 vcc, 6, v8
    s_nop 1
    v_cndmask_b32 v11, 0, 1, vcc
    v_mul_u32_u24 v12, 6, v11
    v_sub_u32 v8, v8, v12
    v_lshl_add_u32 v11, v11, 2, v7
    v_mul_lo_u32 v11, v11, s54
    v_lshl_add_u32 v12, v8, 6, v9
    v_add_u32 v11, v11, v12
    v_cmp_gt_u32 vcc, s55, v8
    s_nop 1
    v_cndmask_b32 v3, v10, v11, vcc
    s_add_u32 m0, s47, 0
    s_nop 0
    buffer_load_dwordx4 v1, s[20:23], s41 offen lds
    s_add_u32 m0, s47, 1024
    s_nop 0
    buffer_load_dwordx4 v2, s[20:23], s41 offen lds
    s_add_u32 m0, s47, 2048
    s_nop 0
    buffer_load_dwordx4 v3, s[20:23], s41 offen lds
    s_add_u32 s47, s47, 24576
    s_cmp_ge_u32 s47, s66
    s_cselect_b32 s47, s59, s47
    s_add_u32 s41, s41, s44
    s_min_u32 s41, s41, s53
    s_add_u32 m0, s47, 0
    s_nop 0
    buffer_load_dwordx4 v1, s[20:23], s41 offen lds
    s_add_u32 m0, s47, 1024
    s_nop 0
    buffer_load_dwordx4 v2, s[20:23], s41 offen lds
    s_add_u32 m0, s47, 2048
    s_nop 0
    buffer_load_dwordx4 v3, s[20:23], s41 offen lds
    s_add_u32 s47, s47, 24576
    s_cmp_ge_u32 s47, s66
    s_cselect_b32 s47, s59, s47
    s_add_u32 s41, s41, s44
    s_min_u32 s41, s41, s53
    s_add_u32 m0, s47, 0
    s_nop 0
    buffer_load_dwordx4 v1, s[20:23], s41 offen lds
    s_add_u32 m0, s47, 1024
    s_nop 0
    buffer_load_dwordx4 v2, s[20:23], s41 offen lds
    s_add_u32 m0, s47, 2048
    s_nop 0
    buffer_load_dwordx4 v3, s[20:23], s41 offen lds
    v_lshrrev_b32 v8, 5, v0
    v_mul_u32_u24 v8, 3072, v8
    v_bfe_u32 v9, v0, 2, 2
    v_lshl_add_u32 v8, v9, 6, v8
    v_bfe_u32 v9, v0, 4, 1
    v_and_b32 v10, 3, v0
    s_mul_i32 s54, s40, 12288
    s_mul_i32 s56, s40, 768
    s_cmp_lt_u32 s37, 4
    s_cbranch_scc1 K1_AQK
    v_lshl_add_u32 v11, v9, 5, v8
    v_lshl_add_u32 v11, v10, 3, v11
    s_cmp_lt_u32 s37, 6
    s_cselect_b32 s54, s54, s56
    v_add_u32 v64, s54, v11
    s_branch K1_A2
K1_AQK:
    v_lshrrev_b32 v12, 1, v10
    v_lshl_add_u32 v12, v9, 1, v12
    v_lshl_add_u32 v12, v12, 3, v8
    v_and_b32 v13, 1, v10
    v_mul_u32_u24 v14, 544, v13
    v_add3_u32 v64, v12, v14, s54
    v_mul_u32_u24 v14, 736, v13
    v_add_u32 v14, 32, v14
    v_add3_u32 v66, v12, v14, s54
    v_xor_b32 v67, 0xc000, v66
K1_A2:
    v_xor_b32 v65, 0xc000, v64
    s_lshl_b32 s54, s39, 12
    s_add_u32 s54, s54, 98304
    v_and_b32 v8, 31, v0
    v_lshlrev_b32 v8, 7, v8
    v_add_u32 v8, s54, v8
    v_lshrrev_b32 v9, 5, v0
    v_bfe_u32 v10, v0, 1, 3
    v_add_u32 v11, 0, v9
    v_xor_b32 v11, v11, v10
    v_lshl_add_u32 v68, v11, 4, v8
    v_add_u32 v11, 2, v9
    v_xor_b32 v11, v11, v10
    v_lshl_add_u32 v69, v11, 4, v8
    v_add_u32 v11, 4, v9
    v_xor_b32 v11, v11, v10
    v_lshl_add_u32 v70, v11, 4, v8
    v_add_u32 v11, 6, v9
    v_xor_b32 v11, v11, v10
    v_lshl_add_u32 v71, v11, 4, v8
    v_mov_b64 v[80:81], 0
    v_mov_b64 v[82:83], 0
    v_mov_b64 v[84:85], 0
    v_mov_b64 v[86:87], 0
    v_mov_b64 v[88:89], 0
    v_mov_b64 v[90:91], 0
    v_mov_b64 v[92:93], 0
    v_mov_b64 v[94:95], 0
    v_mov_b64 v[96:97], 0
    v_mov_b64 v[98:99], 0
    v_mov_b64 v[100:101], 0
    v_mov_b64 v[102:103], 0
    v_mov_b64 v[104:105], 0
    v_mov_b64 v[106:107], 0
    v_mov_b64 v[108:109], 0
    v_mov_b64 v[110:111], 0
    v_mov_b64 v[112:113], 0
    v_mov_b64 v[114:115], 0
    v_mov_b64 v[116:117], 0
    v_mov_b64 v[118:119], 0
    v_mov_b64 v[120:121], 0
    v_mov_b64 v[122:123], 0
    v_mov_b64 v[124:125], 0
    v_mov_b64 v[126:127], 0
    v_mov_b64 v[128:129], 0
    v_mov_b64 v[130:131], 0
    v_mov_b64 v[132:133], 0
    v_mov_b64 v[134:135], 0
    v_mov_b64 v[136:137], 0
    v_mov_b64 v[138:139], 0
    v_mov_b64 v[140:141], 0
    v_mov_b64 v[142:143], 0
    v_mov_b64 v[144:145], 0
    v_mov_b64 v[146:147], 0
    v_mov_b64 v[148:149], 0
    v_mov_b64 v[150:151], 0
    v_mov_b64 v[152:153], 0
    v_mov_b64 v[154:155], 0
    v_mov_b64 v[156:157], 0
    v_mov_b64 v[158:159], 0
    v_mov_b64 v[160:161], 0
    v_mov_b64 v[162:163], 0
    v_mov_b64 v[164:165], 0
    v_mov_b64 v[166:167], 0
    v_mov_b64 v[168:169], 0
    v_mov_b64 v[170:171], 0
    v_mov_b64 v[172:173], 0
    v_mov_b64 v[174:175], 0
    v_mov_b64 v[8:9], 0
    v_mov_b64 v[10:11], 0
    v_mov_b64 v[12:13], 0
    v_mov_b64 v[14:15], 0
    s_mov_b32 s49, 0
    s_mov_b32 s69, 0
    s_mov_b32 s51, 16384
    s_mov_b32 s57, 16384
    s_mov_b32 s50, 16384
    s_mov_b32 s68, 16
    s_mov_b32 s54, 0x3f803f80
    s_waitcnt vmcnt(27)
    v_dot2_f32_bf16 v8, v176, s54, v8
    v_dot2_f32_bf16 v10, v176, v176, v10
    v_dot2_f32_bf16 v9, v177, s54, v9
    v_dot2_f32_bf16 v11, v177, v177, v11
    v_dot2_f32_bf16 v8, v178, s54, v8
    v_dot2_f32_bf16 v10, v178, v178, v10
    v_dot2_f32_bf16 v9, v179, s54, v9
    v_dot2_f32_bf16 v11, v179, v179, v11
    v_dot2_f32_bf16 v12, v180, s54, v12
    v_dot2_f32_bf16 v14, v180, v180, v14
    v_dot2_f32_bf16 v13, v181, s54, v13
    v_dot2_f32_bf16 v15, v181, v181, v15
    v_dot2_f32_bf16 v12, v182, s54, v12
    v_dot2_f32_bf16 v14, v182, v182, v14
    v_dot2_f32_bf16 v13, v183, s54, v13
    v_dot2_f32_bf16 v15, v183, v183, v15
    s_waitcnt vmcnt(25)
    v_dot2_f32_bf16 v8, v184, s54, v8
    v_dot2_f32_bf16 v10, v184, v184, v10
    v_dot2_f32_bf16 v9, v185, s54, v9
    v_dot2_f32_bf16 v11, v185, v185, v11
    v_dot2_f32_bf16 v8, v186, s54, v8
    v_dot2_f32_bf16 v10, v186, v186, v10
    v_dot2_f32_bf16 v9, v187, s54, v9
    v_dot2_f32_bf16 v11, v187, v187, v11
    v_dot2_f32_bf16 v12, v188, s54, v12
    v_dot2_f32_bf16 v14, v188, v188, v14
    v_dot2_f32_bf16 v13, v189, s54, v13
    v_dot2_f32_bf16 v15, v189, v189, v15
    v_dot2_f32_bf16 v12, v190, s54, v12
    v_dot2_f32_bf16 v14, v190, v190, v14
    v_dot2_f32_bf16 v13, v191, s54, v13
    v_dot2_f32_bf16 v15, v191, v191, v15
    s_waitcnt vmcnt(23)
    v_dot2_f32_bf16 v8, v192, s54, v8
    v_dot2_f32_bf16 v10, v192, v192, v10
    v_dot2_f32_bf16 v9, v193, s54, v9
    v_dot2_f32_bf16 v11, v193, v193, v11
    v_dot2_f32_bf16 v8, v194, s54, v8
    v_dot2_f32_bf16 v10, v194, v194, v10
    v_dot2_f32_bf16 v9, v195, s54, v9
    v_dot2_f32_bf16 v11, v195, v195, v11
    v_dot2_f32_bf16 v12, v196, s54, v12
    v_dot2_f32_bf16 v14, v196, v196, v14
    v_dot2_f32_bf16 v13, v197, s54, v13
    v_dot2_f32_bf16 v15, v197, v197, v15
    v_dot2_f32_bf16 v12, v198, s54, v12
    v_dot2_f32_bf16 v14, v198, v198, v14
    v_dot2_f32_bf16 v13, v199, s54, v13
    v_dot2_f32_bf16 v15, v199, v199, v15
    s_waitcnt vmcnt(21)
    v_dot2_f32_bf16 v8, v200, s54, v8
    v_dot2_f32_bf16 v10, v200, v200, v10
    v_dot2_f32_bf16 v9, v201, s54, v9
    v_dot2_f32_bf16 v11, v201, v201, v11
    v_dot2_f32_bf16 v8, v202, s54, v8
    v_dot2_f32_bf16 v10, v202, v202, v10
    v_dot2_f32_bf16 v9, v203, s54, v9
    v_dot2_f32_bf16 v11, v203, v203, v11
    v_dot2_f32_bf16 v12, v204, s54, v12
    v_dot2_f32_bf16 v14, v204, v204, v14
    v_dot2_f32_bf16 v13, v205, s54, v13
    v_dot2_f32_bf16 v15, v205, v205, v15
    v_dot2_f32_bf16 v12, v206, s54, v12
    v_dot2_f32_bf16 v14, v206, v206, v14
    v_dot2_f32_bf16 v13, v207, s54, v13
    v_dot2_f32_bf16 v15, v207, v207, v15
    s_waitcnt vmcnt(19)
    v_dot2_f32_bf16 v8, v208, s54, v8
    v_dot2_f32_bf16 v10, v208, v208, v10
    v_dot2_f32_bf16 v9, v209, s54, v9
    v_dot2_f32_bf16 v11, v209, v209, v11
    v_dot2_f32_bf16 v8, v210, s54, v8
    v_dot2_f32_bf16 v10, v210, v210, v10
    v_dot2_f32_bf16 v9, v211, s54, v9
    v_dot2_f32_bf16 v11, v211, v211, v11
    v_dot2_f32_bf16 v12, v212, s54, v12
    v_dot2_f32_bf16 v14, v212, v212, v14
    v_dot2_f32_bf16 v13, v213, s54, v13
    v_dot2_f32_bf16 v15, v213, v213, v15
    v_dot2_f32_bf16 v12, v214, s54, v12
    v_dot2_f32_bf16 v14, v214, v214, v14
    v_dot2_f32_bf16 v13, v215, s54, v13
    v_dot2_f32_bf16 v15, v215, v215, v15
    s_waitcnt vmcnt(17)
    v_dot2_f32_bf16 v8, v216, s54, v8
    v_dot2_f32_bf16 v10, v216, v216, v10
    v_dot2_f32_bf16 v9, v217, s54, v9
    v_dot2_f32_bf16 v11, v217, v217, v11
    v_dot2_f32_bf16 v8, v218, s54, v8
    v_dot2_f32_bf16 v10, v218, v218, v10
    v_dot2_f32_bf16 v9, v219, s54, v9
    v_dot2_f32_bf16 v11, v219, v219, v11
    v_dot2_f32_bf16 v12, v220, s54, v12
    v_dot2_f32_bf16 v14, v220, v220, v14
    v_dot2_f32_bf16 v13, v221, s54, v13
    v_dot2_f32_bf16 v15, v221, v221, v15
    v_dot2_f32_bf16 v12, v222, s54, v12
    v_dot2_f32_bf16 v14, v222, v222, v14
    v_dot2_f32_bf16 v13, v223, s54, v13
    v_dot2_f32_bf16 v15, v223, v223, v15
    s_waitcnt vmcnt(15)
    v_dot2_f32_bf16 v8, v224, s54, v8
    v_dot2_f32_bf16 v10, v224, v224, v10
    v_dot2_f32_bf16 v9, v225, s54, v9
    v_dot2_f32_bf16 v11, v225, v225, v11
    v_dot2_f32_bf16 v8, v226, s54, v8
    v_dot2_f32_bf16 v10, v226, v226, v10
    v_dot2_f32_bf16 v9, v227, s54, v9
    v_dot2_f32_bf16 v11, v227, v227, v11
    v_dot2_f32_bf16 v12, v228, s54, v12
    v_dot2_f32_bf16 v14, v228, v228, v14
    v_dot2_f32_bf16 v13, v229, s54, v13
    v_dot2_f32_bf16 v15, v229, v229, v15
    v_dot2_f32_bf16 v12, v230, s54, v12
    v_dot2_f32_bf16 v14, v230, v230, v14
    v_dot2_f32_bf16 v13, v231, s54, v13
    v_dot2_f32_bf16 v15, v231, v231, v15
    s_waitcnt vmcnt(13)
    v_dot2_f32_bf16 v8, v232, s54, v8
    v_dot2_f32_bf16 v10, v232, v232, v10
    v_dot2_f32_bf16 v9, v233, s54, v9
    v_dot2_f32_bf16 v11, v233, v233, v11
    v_dot2_f32_bf16 v8, v234, s54, v8
    v_dot2_f32_bf16 v10, v234, v234, v10
    v_dot2_f32_bf16 v9, v235, s54, v9
    v_dot2_f32_bf16 v11, v235, v235, v11
    v_dot2_f32_bf16 v12, v236, s54, v12
    v_dot2_f32_bf16 v14, v236, v236, v14
    v_dot2_f32_bf16 v13, v237, s54, v13
    v_dot2_f32_bf16 v15, v237, v237, v15
    v_dot2_f32_bf16 v12, v238, s54, v12
    v_dot2_f32_bf16 v14, v238, v238, v14
    v_dot2_f32_bf16 v13, v239, s54, v13
    v_dot2_f32_bf16 v15, v239, v239, v15
    s_waitcnt vmcnt(11)
    v_dot2_f32_bf16 v8, v240, s54, v8
    v_dot2_f32_bf16 v10, v240, v240, v10
    v_dot2_f32_bf16 v9, v241, s54, v9
    v_dot2_f32_bf16 v11, v241, v241, v11
    v_dot2_f32_bf16 v8, v242, s54, v8
    v_dot2_f32_bf16 v10, v242, v242, v10
    v_dot2_f32_bf16 v9, v243, s54, v9
    v_dot2_f32_bf16 v11, v243, v243, v11
    v_dot2_f32_bf16 v12, v244, s54, v12
    v_dot2_f32_bf16 v14, v244, v244, v14
    v_dot2_f32_bf16 v13, v245, s54, v13
    v_dot2_f32_bf16 v15, v245, v245, v15
    v_dot2_f32_bf16 v12, v246, s54, v12
    v_dot2_f32_bf16 v14, v246, v246, v14
    v_dot2_f32_bf16 v13, v247, s54, v13
    v_dot2_f32_bf16 v15, v247, v247, v15
    s_waitcnt vmcnt(9)
    v_dot2_f32_bf16 v8, v248, s54, v8
    v_dot2_f32_bf16 v10, v248, v248, v10
    v_dot2_f32_bf16 v9, v249, s54, v9
    v_dot2_f32_bf16 v11, v249, v249, v11
    v_dot2_f32_bf16 v8, v250, s54, v8
    v_dot2_f32_bf16 v10, v250, v250, v10
    v_dot2_f32_bf16 v9, v251, s54, v9
    v_dot2_f32_bf16 v11, v251, v251, v11
    v_dot2_f32_bf16 v12, v252, s54, v12
    v_dot2_f32_bf16 v14, v252, v252, v14
    v_dot2_f32_bf16 v13, v253, s54, v13
    v_dot2_f32_bf16 v15, v253, v253, v15
    v_dot2_f32_bf16 v12, v254, s54, v12
    v_dot2_f32_bf16 v14, v254, v254, v14
    v_dot2_f32_bf16 v13, v255, s54, v13
    v_dot2_f32_bf16 v15, v255, v255, v15
    s_nop 2
    v_add_f32 v8, v8, v9
    v_add_f32 v10, v10, v11
    v_add_f32 v12, v12, v13
    v_add_f32 v14, v14, v15
    s_nop 1
    v_add_f32_dpp v8, v8, v8 quad_perm:[1,0,3,2] row_mask:0xf bank_mask:0xf
    v_add_f32_dpp v10, v10, v10 quad_perm:[1,0,3,2] row_mask:0xf bank_mask:0xf
    v_add_f32_dpp v12, v12, v12 quad_perm:[1,0,3,2] row_mask:0xf bank_mask:0xf
    v_add_f32_dpp v14, v14, v14 quad_perm:[1,0,3,2] row_mask:0xf bank_mask:0xf
    s_nop 1
    v_add_f32_dpp v8, v8, v8 quad_perm:[2,3,0,1] row_mask:0xf bank_mask:0xf
    v_add_f32_dpp v10, v10, v10 quad_perm:[2,3,0,1] row_mask:0xf bank_mask:0xf
    v_add_f32_dpp v12, v12, v12 quad_perm:[2,3,0,1] row_mask:0xf bank_mask:0xf
    v_add_f32_dpp v14, v14, v14 quad_perm:[2,3,0,1] row_mask:0xf bank_mask:0xf
    s_nop 1
    v_add_f32_dpp v8, v8, v8 row_half_mirror row_mask:0xf bank_mask:0xf
    v_add_f32_dpp v10, v10, v10 row_half_mirror row_mask:0xf bank_mask:0xf
    v_add_f32_dpp v12, v12, v12 row_half_mirror row_mask:0xf bank_mask:0xf
    v_add_f32_dpp v14, v14, v14 row_half_mirror row_mask:0xf bank_mask:0xf
    v_mul_f32 v8, 0x3acccccd, v8
    v_mul_f32 v10, 0x3acccccd, v10
    v_fma_f32 v10, -v8, v8, v10
    v_max_f32 v10, 0, v10
    v_cvt_pk_bf16_f32 v10, v10, v10
    v_and_b32 v10, 0xffff0000, v10
    v_add_f32 v10, 0x3727c5ac, v10
    v_cvt_pk_bf16_f32 v10, v10, v10
    v_and_b32 v10, 0xffff0000, v10
    v_sqrt_f32 v10, v10
    v_cvt_pk_bf16_f32 v8, v8, v8
    v_and_b32 v8, 0xffff0000, v8
    v_cvt_pk_bf16_f32 v10, v10, v10
    v_and_b32 v10, 0xffff0000, v10
    v_rcp_f32 v76, v10
    s_nop 0
    v_mul_f32 v77, v8, v76
    v_sub_f32 v77, 0, v77
    v_mul_f32 v12, 0x3acccccd, v12
    v_mul_f32 v14, 0x3acccccd, v14
    v_fma_f32 v14, -v12, v12, v14
    v_max_f32 v14, 0, v14
    v_cvt_pk_bf16_f32 v14, v14, v14
    v_and_b32 v14, 0xffff0000, v14
    v_add_f32 v14, 0x3727c5ac, v14
    v_cvt_pk_bf16_f32 v14, v14, v14
    v_and_b32 v14, 0xffff0000, v14
    v_sqrt_f32 v14, v14
    v_cvt_pk_bf16_f32 v12, v12, v12
    v_and_b32 v12, 0xffff0000, v12
    v_cvt_pk_bf16_f32 v14, v14, v14
    v_and_b32 v14, 0xffff0000, v14
    v_rcp_f32 v78, v14
    s_nop 0
    v_mul_f32 v79, v12, v78
    v_sub_f32 v79, 0, v79
    v_lshlrev_b32 v40, 16, v176
    v_and_b32 v41, s52, v176
    v_lshlrev_b32 v42, 16, v177
    v_and_b32 v43, s52, v177
    v_fma_f32 v40, v40, v76, v77
    v_fma_f32 v41, v41, v76, v77
    v_fma_f32 v42, v42, v76, v77
    v_fma_f32 v43, v43, v76, v77
    v_cvt_pk_bf16_f32 v48, v40, v41
    v_cvt_pk_bf16_f32 v49, v42, v43
    v_lshlrev_b32 v44, 16, v178
    v_and_b32 v45, s52, v178
    v_lshlrev_b32 v46, 16, v179
    v_and_b32 v47, s52, v179
    v_fma_f32 v44, v44, v76, v77
    v_fma_f32 v45, v45, v76, v77
    v_fma_f32 v46, v46, v76, v77
    v_fma_f32 v47, v47, v76, v77
    v_cvt_pk_bf16_f32 v50, v44, v45
    v_cvt_pk_bf16_f32 v51, v46, v47
    ds_write_b128 v74, v[48:51]
    v_add_u32 v74, s51, v74
    v_lshlrev_b32 v40, 16, v180
    v_and_b32 v41, s52, v180
    v_lshlrev_b32 v42, 16, v181
    v_and_b32 v43, s52, v181
    v_fma_f32 v40, v40, v78, v79
    v_fma_f32 v41, v41, v78, v79
    v_fma_f32 v42, v42, v78, v79
    v_fma_f32 v43, v43, v78, v79
    v_cvt_pk_bf16_f32 v52, v40, v41
    v_cvt_pk_bf16_f32 v53, v42, v43
    v_lshlrev_b32 v44, 16, v182
    v_and_b32 v45, s52, v182
    v_lshlrev_b32 v46, 16, v183
    v_and_b32 v47, s52, v183
    v_fma_f32 v44, v44, v78, v79
    v_fma_f32 v45, v45, v78, v79
    v_fma_f32 v46, v46, v78, v79
    v_fma_f32 v47, v47, v78, v79
    v_cvt_pk_bf16_f32 v54, v44, v45
    v_cvt_pk_bf16_f32 v55, v46, v47
    ds_write_b128 v75, v[52:55]
    v_add_u32 v75, s51, v75
    v_lshlrev_b32 v40, 16, v184
    v_and_b32 v41, s52, v184
    v_lshlrev_b32 v42, 16, v185
    v_and_b32 v43, s52, v185
    v_fma_f32 v40, v40, v76, v77
    v_fma_f32 v41, v41, v76, v77
    v_fma_f32 v42, v42, v76, v77
    v_fma_f32 v43, v43, v76, v77
    v_cvt_pk_bf16_f32 v48, v40, v41
    v_cvt_pk_bf16_f32 v49, v42, v43
    v_lshlrev_b32 v44, 16, v186
    v_and_b32 v45, s52, v186
    v_lshlrev_b32 v46, 16, v187
    v_and_b32 v47, s52, v187
    v_fma_f32 v44, v44, v76, v77
    v_fma_f32 v45, v45, v76, v77
    v_fma_f32 v46, v46, v76, v77
    v_fma_f32 v47, v47, v76, v77
    v_cvt_pk_bf16_f32 v50, v44, v45
    v_cvt_pk_bf16_f32 v51, v46, v47
    ds_write_b128 v74, v[48:51]
    v_add_u32 v74, s51, v74
    v_lshlrev_b32 v40, 16, v188
    v_and_b32 v41, s52, v188
    v_lshlrev_b32 v42, 16, v189
    v_and_b32 v43, s52, v189
    v_fma_f32 v40, v40, v78, v79
    v_fma_f32 v41, v41, v78, v79
    v_fma_f32 v42, v42, v78, v79
    v_fma_f32 v43, v43, v78, v79
    v_cvt_pk_bf16_f32 v52, v40, v41
    v_cvt_pk_bf16_f32 v53, v42, v43
    v_lshlrev_b32 v44, 16, v190
    v_and_b32 v45, s52, v190
    v_lshlrev_b32 v46, 16, v191
    v_and_b32 v47, s52, v191
    v_fma_f32 v44, v44, v78, v79
    v_fma_f32 v45, v45, v78, v79
    v_fma_f32 v46, v46, v78, v79
    v_fma_f32 v47, v47, v78, v79
    v_cvt_pk_bf16_f32 v54, v44, v45
    v_cvt_pk_bf16_f32 v55, v46, v47
    ds_write_b128 v75, v[52:55]
    v_add_u32 v75, s51, v75
    s_mov_b32 s51, 0xffff8000
    s_waitcnt vmcnt(6) lgkmcnt(0)
    s_barrier
    s_cmp_lt_u32 s37, 4
    s_cbranch_scc1 K1_QK
    s_cmp_lt_u32 s37, 6
    s_cbranch_scc1 K1_V
K1_GU:
    ds_read_b128 v[32:35], v68
    v_add_u32 v68, s50, v68
    ds_read_b64_tr_b16 v[8:9], v64 offset:0
    ds_read_b64_tr_b16 v[10:11], v64 offset:1536
    ds_read_b64_tr_b16 v[12:13], v64 offset:256
    ds_read_b64_tr_b16 v[14:15], v64 offset:1792
    ds_read_b64_tr_b16 v[16:17], v64 offset:512
    ds_read_b64_tr_b16 v[18:19], v64 offset:2048
    ds_read_b64_tr_b16 v[20:21], v64 offset:12288
    ds_read_b64_tr_b16 v[22:23], v64 offset:13824
    ds_read_b64_tr_b16 v[24:25], v64 offset:12544
    ds_read_b64_tr_b16 v[26:27], v64 offset:14080
    ds_read_b64_tr_b16 v[28:29], v64 offset:12800
    ds_read_b64_tr_b16 v[30:31], v64 offset:14336
    ds_read_b64_tr_b16 v[56:57], v64 offset:6144
    ds_read_b64_tr_b16 v[58:59], v64 offset:7680
    ds_read_b64_tr_b16 v[60:61], v64 offset:6400
    ds_read_b64_tr_b16 v[62:63], v64 offset:7936
    ds_read_b64_tr_b16 v[176:177], v64 offset:6656
    ds_read_b64_tr_b16 v[178:179], v64 offset:8192
    ds_read_b64_tr_b16 v[180:181], v64 offset:18432
    ds_read_b64_tr_b16 v[182:183], v64 offset:19968
    ds_read_b64_tr_b16 v[184:185], v64 offset:18688
    ds_read_b64_tr_b16 v[186:187], v64 offset:20224
    ds_read_b64_tr_b16 v[188:189], v64 offset:18944
    ds_read_b64_tr_b16 v[190:191], v64 offset:20480
K1LOOP_1001:
    s_waitcnt vmcnt(3)
    s_barrier
    s_waitcnt lgkmcnt(12)
    v_mfma_f32_32x32x16_bf16 v[80:95], v[8:11], v[32:35], v[80:95]
    ds_read_b128 v[36:39], v69
    v_add_u32 v69, s50, v69
    ds_read_b64_tr_b16 v[8:9], v64 offset:24576
    ds_read_b64_tr_b16 v[10:11], v64 offset:26112
    s_add_u32 s47, s47, 24576
    s_cmp_ge_u32 s47, s66
    s_cselect_b32 s47, s59, s47
    s_add_u32 s41, s41, s44
    s_min_u32 s41, s41, s53
    s_add_u32 m0, s47, 0
    s_nop 0
    buffer_load_dwordx4 v1, s[20:23], s41 offen lds
    v_mfma_f32_32x32x16_bf16 v[96:111], v[12:15], v[32:35], v[96:111]
    ds_read_b64_tr_b16 v[12:13], v64 offset:24832
    ds_read_b64_tr_b16 v[14:15], v64 offset:26368
    s_set_gpr_idx_on s68, gpr_idx(SRC0)
    v_mov_b32 v48, v176
    v_mov_b32 v49, v177
    v_mov_b32 v50, v178
    v_mov_b32 v51, v179
    v_mov_b32 v52, v180
    v_mov_b32 v53, v181
    v_mov_b32 v54, v182
    v_mov_b32 v55, v183
    s_set_gpr_idx_off
    v_lshlrev_b32 v40, 16, v48
    v_and_b32 v41, s52, v48
    v_lshlrev_b32 v42, 16, v49
    v_and_b32 v43, s52, v49
    v_mfma_f32_32x32x16_bf16 v[112:127], v[16:19], v[32:35], v[112:127]
    ds_read_b64_tr_b16 v[16:17], v64 offset:25088
    ds_read_b64_tr_b16 v[18:19], v64 offset:26624
    s_add_u32 m0, s47, 1024
    s_nop 0
    buffer_load_dwordx4 v2, s[20:23], s41 offen lds
    v_mfma_f32_32x32x16_bf16 v[128:143], v[20:23], v[32:35], v[128:143]
    ds_read_b64_tr_b16 v[20:21], v64 offset:36864
    ds_read_b64_tr_b16 v[22:23], v64 offset:38400
    v_fma_f32 v40, v40, v76, v77
    v_fma_f32 v41, v41, v76, v77
    v_fma_f32 v42, v42, v76, v77
    v_fma_f32 v43, v43, v76, v77
    v_cvt_pk_bf16_f32 v48, v40, v41
    v_cvt_pk_bf16_f32 v49, v42, v43
    v_mfma_f32_32x32x16_bf16 v[144:159], v[24:27], v[32:35], v[144:159]
    ds_read_b64_tr_b16 v[24:25], v64 offset:37120
    ds_read_b64_tr_b16 v[26:27], v64 offset:38656
    s_add_u32 m0, s47, 2048
    s_nop 0
    buffer_load_dwordx4 v3, s[20:23], s41 offen lds
    v_mfma_f32_32x32x16_bf16 v[160:175], v[28:31], v[32:35], v[160:175]
    ds_read_b64_tr_b16 v[28:29], v64 offset:37376
    ds_read_b64_tr_b16 v[30:31], v64 offset:38912
    v_lshlrev_b32 v44, 16, v50
    v_and_b32 v45, s52, v50
    v_lshlrev_b32 v46, 16, v51
    v_and_b32 v47, s52, v51
    v_fma_f32 v44, v44, v76, v77
    v_fma_f32 v45, v45, v76, v77
    v_fma_f32 v46, v46, v76, v77
    v_fma_f32 v47, v47, v76, v77
    s_waitcnt lgkmcnt(12)
    v_mfma_f32_32x32x16_bf16 v[80:95], v[56:59], v[36:39], v[80:95]
    ds_read_b128 v[32:35], v70
    v_add_u32 v70, s50, v70
    ds_read_b64_tr_b16 v[56:57], v64 offset:30720
    ds_read_b64_tr_b16 v[58:59], v64 offset:32256
    v_mfma_f32_32x32x16_bf16 v[96:111], v[60:63], v[36:39], v[96:111]
    ds_read_b64_tr_b16 v[60:61], v64 offset:30976
    ds_read_b64_tr_b16 v[62:63], v64 offset:32512
    v_cvt_pk_bf16_f32 v50, v44, v45
    v_cvt_pk_bf16_f32 v51, v46, v47
    v_mfma_f32_32x32x16_bf16 v[112:127], v[176:179], v[36:39], v[112:127]
    ds_read_b64_tr_b16 v[176:177], v64 offset:31232
    ds_read_b64_tr_b16 v[178:179], v64 offset:32768
    ds_write_b128 v74, v[48:51]
    v_add_u32 v74, s51, v74
    v_mfma_f32_32x32x16_bf16 v[128:143], v[180:183], v[36:39], v[128:143]
    ds_read_b64_tr_b16 v[180:181], v64 offset:43008
    ds_read_b64_tr_b16 v[182:183], v64 offset:44544
    v_lshlrev_b32 v40, 16, v52
    v_and_b32 v41, s52, v52
    v_lshlrev_b32 v42, 16, v53
    v_and_b32 v43, s52, v53
    v_mfma_f32_32x32x16_bf16 v[144:159], v[184:187], v[36:39], v[144:159]
    ds_read_b64_tr_b16 v[184:185], v64 offset:43264
    ds_read_b64_tr_b16 v[186:187], v64 offset:44800
    v_fma_f32 v40, v40, v78, v79
    v_fma_f32 v41, v41, v78, v79
    v_fma_f32 v42, v42, v78, v79
    v_fma_f32 v43, v43, v78, v79
    v_mfma_f32_32x32x16_bf16 v[160:175], v[188:191], v[36:39], v[160:175]
    ds_read_b64_tr_b16 v[188:189], v64 offset:43520
    ds_read_b64_tr_b16 v[190:191], v64 offset:45056
    v_cvt_pk_bf16_f32 v52, v40, v41
    v_cvt_pk_bf16_f32 v53, v42, v43
    s_waitcnt vmcnt(3)
    s_barrier
    s_waitcnt lgkmcnt(12)
    v_mfma_f32_32x32x16_bf16 v[80:95], v[8:11], v[32:35], v[80:95]
    ds_read_b128 v[36:39], v71
    v_add_u32 v71, s50, v71
    ds_read_b64_tr_b16 v[8:9], v65 offset:0
    ds_read_b64_tr_b16 v[10:11], v65 offset:1536
    s_add_u32 s47, s47, 24576
    s_cmp_ge_u32 s47, s66
    s_cselect_b32 s47, s59, s47
    s_add_u32 s41, s41, s44
    s_min_u32 s41, s41, s53
    s_add_u32 m0, s47, 0
    s_nop 0
    buffer_load_dwordx4 v1, s[20:23], s41 offen lds
    v_mfma_f32_32x32x16_bf16 v[96:111], v[12:15], v[32:35], v[96:111]
    ds_read_b64_tr_b16 v[12:13], v65 offset:256
    ds_read_b64_tr_b16 v[14:15], v65 offset:1792
    v_lshlrev_b32 v44, 16, v54
    v_and_b32 v45, s52, v54
    v_lshlrev_b32 v46, 16, v55
    v_and_b32 v47, s52, v55
    v_mfma_f32_32x32x16_bf16 v[112:127], v[16:19], v[32:35], v[112:127]
    ds_read_b64_tr_b16 v[16:17], v65 offset:512
    ds_read_b64_tr_b16 v[18:19], v65 offset:2048
    v_fma_f32 v44, v44, v78, v79
    v_fma_f32 v45, v45, v78, v79
    v_fma_f32 v46, v46, v78, v79
    v_fma_f32 v47, v47, v78, v79
    v_mfma_f32_32x32x16_bf16 v[128:143], v[20:23], v[32:35], v[128:143]
    ds_read_b64_tr_b16 v[20:21], v65 offset:12288
    ds_read_b64_tr_b16 v[22:23], v65 offset:13824
    s_add_u32 m0, s47, 1024
    s_nop 0
    buffer_load_dwordx4 v2, s[20:23], s41 offen lds
    v_mfma_f32_32x32x16_bf16 v[144:159], v[24:27], v[32:35], v[144:159]
    ds_read_b64_tr_b16 v[24:25], v65 offset:12544
    ds_read_b64_tr_b16 v[26:27], v65 offset:14080
    v_cvt_pk_bf16_f32 v54, v44, v45
    v_cvt_pk_bf16_f32 v55, v46, v47
    v_mfma_f32_32x32x16_bf16 v[160:175], v[28:31], v[32:35], v[160:175]
    ds_read_b64_tr_b16 v[28:29], v65 offset:12800
    ds_read_b64_tr_b16 v[30:31], v65 offset:14336
    ds_write_b128 v75, v[52:55]
    v_add_u32 v75, s51, v75
    s_add_u32 m0, s47, 2048
    s_nop 0
    buffer_load_dwordx4 v3, s[20:23], s41 offen lds
    s_add_u32 s69, s69, 1
    s_cmp_eq_u32 s69, 3
    s_cselect_b32 s69, 0, s69
    s_cmp_eq_u32 s69, 2
    s_cselect_b32 s50, 0xffff8000, s57
    s_waitcnt lgkmcnt(12)
    v_mfma_f32_32x32x16_bf16 v[80:95], v[56:59], v[36:39], v[80:95]
    ds_read_b128 v[32:35], v68
    v_add_u32 v68, s50, v68
    ds_read_b64_tr_b16 v[56:57], v65 offset:6144
    ds_read_b64_tr_b16 v[58:59], v65 offset:7680
    v_mfma_f32_32x32x16_bf16 v[96:111], v[60:63], v[36:39], v[96:111]
    ds_read_b64_tr_b16 v[60:61], v65 offset:6400
    ds_read_b64_tr_b16 v[62:63], v65 offset:7936
    v_mfma_f32_32x32x16_bf16 v[112:127], v[176:179], v[36:39], v[112:127]
    ds_read_b64_tr_b16 v[176:177], v65 offset:6656
    ds_read_b64_tr_b16 v[178:179], v65 offset:8192
    v_mfma_f32_32x32x16_bf16 v[128:143], v[180:183], v[36:39], v[128:143]
    ds_read_b64_tr_b16 v[180:181], v65 offset:18432
    ds_read_b64_tr_b16 v[182:183], v65 offset:19968
    v_mfma_f32_32x32x16_bf16 v[144:159], v[184:187], v[36:39], v[144:159]
    ds_read_b64_tr_b16 v[184:185], v65 offset:18688
    ds_read_b64_tr_b16 v[186:187], v65 offset:20224
    v_mfma_f32_32x32x16_bf16 v[160:175], v[188:191], v[36:39], v[160:175]
    ds_read_b64_tr_b16 v[188:189], v65 offset:18944
    ds_read_b64_tr_b16 v[190:191], v65 offset:20480
    v_xor_b32 v64, 0xc000, v64
    v_xor_b32 v65, 0xc000, v65
    s_cmp_eq_u32 s69, 0
    s_cselect_b32 s51, 0xffff8000, s57
    s_add_u32 s68, s68, 8
    s_min_u32 s68, s68, 72
    s_add_u32 s49, s49, 1
    s_cmp_lt_u32 s49, 10
    s_cbranch_scc1 K1LOOP_1001
    s_lshl_b32 s62, s36, 2
    s_add_u32 s62, s62, s39
    v_lshlrev_b32 v72, 4, v0
    s_waitcnt lgkmcnt(0)
    s_add_u32 s32, s16, 0x900000
    s_addc_u32 s33, s17, 0
    s_mov_b32 s34, 0x6c0000
    s_mov_b32 s35, 0x00020000
    s_sub_u32 s54, s37, 6
    s_mul_i32 s54, s54, 6
    s_mul_i32 s55, s40, 3
    s_add_u32 s54, s54, s55
    s_lshl_b32 s54, s54, 11
    s_mul_i32 s55, s62, 110592
    s_add_u32 s55, s55, s54
    s_nop 4
    v_pk_mul_f32 v[80:81], v[80:81], v[128:129]
    v_pk_mul_f32 v[82:83], v[82:83], v[130:131]
    v_pk_mul_f32 v[84:85], v[84:85], v[132:133]
    v_pk_mul_f32 v[86:87], v[86:87], v[134:135]
    v_pk_mul_f32 v[88:89], v[88:89], v[136:137]
    v_pk_mul_f32 v[90:91], v[90:91], v[138:139]
    v_pk_mul_f32 v[92:93], v[92:93], v[140:141]
    v_pk_mul_f32 v[94:95], v[94:95], v[142:143]
    v_cvt_pk_bf16_f32 v8, v80, v81
    v_cvt_pk_bf16_f32 v9, v82, v83
    v_cvt_pk_bf16_f32 v10, v84, v85
    v_cvt_pk_bf16_f32 v11, v86, v87
    v_cvt_pk_bf16_f32 v12, v88, v89
    v_cvt_pk_bf16_f32 v13, v90, v91
    v_cvt_pk_bf16_f32 v14, v92, v93
    v_cvt_pk_bf16_f32 v15, v94, v95
    buffer_store_dwordx4 v[8:11], v72, s[32:35], s55 offen offset:0 sc1
    buffer_store_dwordx4 v[12:15], v72, s[32:35], s55 offen offset:1024 sc1
    s_add_u32 s55, s55, 2048
    v_pk_mul_f32 v[96:97], v[96:97], v[144:145]
    v_pk_mul_f32 v[98:99], v[98:99], v[146:147]
    v_pk_mul_f32 v[100:101], v[100:101], v[148:149]
    v_pk_mul_f32 v[102:103], v[102:103], v[150:151]
    v_pk_mul_f32 v[104:105], v[104:105], v[152:153]
    v_pk_mul_f32 v[106:107], v[106:107], v[154:155]
    v_pk_mul_f32 v[108:109], v[108:109], v[156:157]
    v_pk_mul_f32 v[110:111], v[110:111], v[158:159]
    v_cvt_pk_bf16_f32 v16, v96, v97
    v_cvt_pk_bf16_f32 v17, v98, v99
    v_cvt_pk_bf16_f32 v18, v100, v101
    v_cvt_pk_bf16_f32 v19, v102, v103
    v_cvt_pk_bf16_f32 v20, v104, v105
    v_cvt_pk_bf16_f32 v21, v106, v107
    v_cvt_pk_bf16_f32 v22, v108, v109
    v_cvt_pk_bf16_f32 v23, v110, v111
    buffer_store_dwordx4 v[16:19], v72, s[32:35], s55 offen offset:0 sc1
    buffer_store_dwordx4 v[20:23], v72, s[32:35], s55 offen offset:1024 sc1
    s_add_u32 s55, s55, 2048
    v_pk_mul_f32 v[112:113], v[112:113], v[160:161]
    v_pk_mul_f32 v[114:115], v[114:115], v[162:163]
    v_pk_mul_f32 v[116:117], v[116:117], v[164:165]
    v_pk_mul_f32 v[118:119], v[118:119], v[166:167]
    v_pk_mul_f32 v[120:121], v[120:121], v[168:169]
    v_pk_mul_f32 v[122:123], v[122:123], v[170:171]
    v_pk_mul_f32 v[124:125], v[124:125], v[172:173]
    v_pk_mul_f32 v[126:127], v[126:127], v[174:175]
    v_cvt_pk_bf16_f32 v24, v112, v113
    v_cvt_pk_bf16_f32 v25, v114, v115
    v_cvt_pk_bf16_f32 v26, v116, v117
    v_cvt_pk_bf16_f32 v27, v118, v119
    v_cvt_pk_bf16_f32 v28, v120, v121
    v_cvt_pk_bf16_f32 v29, v122, v123
    v_cvt_pk_bf16_f32 v30, v124, v125
    v_cvt_pk_bf16_f32 v31, v126, v127
    buffer_store_dwordx4 v[24:27], v72, s[32:35], s55 offen offset:0 sc1
    buffer_store_dwordx4 v[28:31], v72, s[32:35], s55 offen offset:1024 sc1
    s_add_u32 s55, s55, 2048
    s_branch K1_FIN
K1_QK:
    ds_read_b128 v[32:35], v68
    v_add_u32 v68, s50, v68
    ds_read_b64_tr_b16 v[8:9], v64 offset:0
    ds_read_b64_tr_b16 v[10:11], v64 offset:1536
    ds_read_b64_tr_b16 v[12:13], v66 offset:0
    ds_read_b64_tr_b16 v[14:15], v66 offset:1536
    ds_read_b64_tr_b16 v[16:17], v64 offset:256
    ds_read_b64_tr_b16 v[18:19], v64 offset:1792
    ds_read_b64_tr_b16 v[20:21], v66 offset:256
    ds_read_b64_tr_b16 v[22:23], v66 offset:1792
    ds_read_b64_tr_b16 v[24:25], v64 offset:512
    ds_read_b64_tr_b16 v[26:27], v64 offset:2048
    ds_read_b64_tr_b16 v[56:57], v64 offset:6144
    ds_read_b64_tr_b16 v[58:59], v64 offset:7680
    ds_read_b64_tr_b16 v[60:61], v66 offset:6144
    ds_read_b64_tr_b16 v[62:63], v66 offset:7680
    ds_read_b64_tr_b16 v[176:177], v64 offset:6400
    ds_read_b64_tr_b16 v[178:179], v64 offset:7936
    ds_read_b64_tr_b16 v[180:181], v66 offset:6400
    ds_read_b64_tr_b16 v[182:183], v66 offset:7936
    ds_read_b64_tr_b16 v[184:185], v64 offset:6656
    ds_read_b64_tr_b16 v[186:187], v64 offset:8192
K1LOOP_1002:
    s_waitcnt vmcnt(3)
    s_barrier
    s_waitcnt lgkmcnt(10)
    v_mfma_f32_32x32x16_bf16 v[80:95], v[8:11], v[32:35], v[80:95]
    ds_read_b128 v[36:39], v69
    v_add_u32 v69, s50, v69
    ds_read_b64_tr_b16 v[8:9], v64 offset:24576
    ds_read_b64_tr_b16 v[10:11], v64 offset:26112
    s_add_u32 s47, s47, 24576
    s_cmp_ge_u32 s47, s66
    s_cselect_b32 s47, s59, s47
    s_add_u32 s41, s41, s44
    s_min_u32 s41, s41, s53
    s_add_u32 m0, s47, 0
    s_nop 0
    buffer_load_dwordx4 v1, s[20:23], s41 offen lds
    v_mfma_f32_32x32x16_bf16 v[96:111], v[12:15], v[32:35], v[96:111]
    ds_read_b64_tr_b16 v[12:13], v66 offset:24576
    ds_read_b64_tr_b16 v[14:15], v66 offset:26112
    s_set_gpr_idx_on s68, gpr_idx(SRC0)
    v_mov_b32 v48, v176
    v_mov_b32 v49, v177
    v_mov_b32 v50, v178
    v_mov_b32 v51, v179
    v_mov_b32 v52, v180
    v_mov_b32 v53, v181
    v_mov_b32 v54, v182
    v_mov_b32 v55, v183
    s_set_gpr_idx_off
    v_lshlrev_b32 v40, 16, v48
    v_and_b32 v41, s52, v48
    v_lshlrev_b32 v42, 16, v49
    v_and_b32 v43, s52, v49
    v_mfma_f32_32x32x16_bf16 v[112:127], v[16:19], v[32:35], v[112:127]
    ds_read_b64_tr_b16 v[16:17], v64 offset:24832
    ds_read_b64_tr_b16 v[18:19], v64 offset:26368
    s_add_u32 m0, s47, 1024
    s_nop 0
    buffer_load_dwordx4 v2, s[20:23], s41 offen lds
    v_fma_f32 v40, v40, v76, v77
    v_fma_f32 v41, v41, v76, v77
    v_fma_f32 v42, v42, v76, v77
    v_fma_f32 v43, v43, v76, v77
    v_mfma_f32_32x32x16_bf16 v[128:143], v[20:23], v[32:35], v[128:143]
    ds_read_b64_tr_b16 v[20:21], v66 offset:24832
    ds_read_b64_tr_b16 v[22:23], v66 offset:26368
    v_cvt_pk_bf16_f32 v48, v40, v41
    v_cvt_pk_bf16_f32 v49, v42, v43
    s_add_u32 m0, s47, 2048
    s_nop 0
    buffer_load_dwordx4 v3, s[20:23], s41 offen lds
    v_mfma_f32_32x32x16_bf16 v[144:159], v[24:27], v[32:35], v[144:159]
    ds_read_b64_tr_b16 v[24:25], v64 offset:25088
    ds_read_b64_tr_b16 v[26:27], v64 offset:26624
    v_lshlrev_b32 v44, 16, v50
    v_and_b32 v45, s52, v50
    v_lshlrev_b32 v46, 16, v51
    v_and_b32 v47, s52, v51
    v_fma_f32 v44, v44, v76, v77
    v_fma_f32 v45, v45, v76, v77
    v_fma_f32 v46, v46, v76, v77
    v_fma_f32 v47, v47, v76, v77
    s_waitcnt lgkmcnt(10)
    v_mfma_f32_32x32x16_bf16 v[80:95], v[56:59], v[36:39], v[80:95]
    ds_read_b128 v[32:35], v70
    v_add_u32 v70, s50, v70
    ds_read_b64_tr_b16 v[56:57], v64 offset:30720
    ds_read_b64_tr_b16 v[58:59], v64 offset:32256
    v_cvt_pk_bf16_f32 v50, v44, v45
    v_cvt_pk_bf16_f32 v51, v46, v47
    v_mfma_f32_32x32x16_bf16 v[96:111], v[60:63], v[36:39], v[96:111]
    ds_read_b64_tr_b16 v[60:61], v66 offset:30720
    ds_read_b64_tr_b16 v[62:63], v66 offset:32256
    ds_write_b128 v74, v[48:51]
    v_add_u32 v74, s51, v74
    v_mfma_f32_32x32x16_bf16 v[112:127], v[176:179], v[36:39], v[112:127]
    ds_read_b64_tr_b16 v[176:177], v64 offset:30976
    ds_read_b64_tr_b16 v[178:179], v64 offset:32512
    v_lshlrev_b32 v40, 16, v52
    v_and_b32 v41, s52, v52
    v_lshlrev_b32 v42, 16, v53
    v_and_b32 v43, s52, v53
    v_mfma_f32_32x32x16_bf16 v[128:143], v[180:183], v[36:39], v[128:143]
    ds_read_b64_tr_b16 v[180:181], v66 offset:30976
    ds_read_b64_tr_b16 v[182:183], v66 offset:32512
    v_fma_f32 v40, v40, v78, v79
    v_fma_f32 v41, v41, v78, v79
    v_fma_f32 v42, v42, v78, v79
    v_fma_f32 v43, v43, v78, v79
    v_mfma_f32_32x32x16_bf16 v[144:159], v[184:187], v[36:39], v[144:159]
    ds_read_b64_tr_b16 v[184:185], v64 offset:31232
    ds_read_b64_tr_b16 v[186:187], v64 offset:32768
    v_cvt_pk_bf16_f32 v52, v40, v41
    v_cvt_pk_bf16_f32 v53, v42, v43
    s_waitcnt vmcnt(3)
    s_barrier
    s_waitcnt lgkmcnt(10)
    v_mfma_f32_32x32x16_bf16 v[80:95], v[8:11], v[32:35], v[80:95]
    ds_read_b128 v[36:39], v71
    v_add_u32 v71, s50, v71
    ds_read_b64_tr_b16 v[8:9], v65 offset:0
    ds_read_b64_tr_b16 v[10:11], v65 offset:1536
    s_add_u32 s47, s47, 24576
    s_cmp_ge_u32 s47, s66
    s_cselect_b32 s47, s59, s47
    s_add_u32 s41, s41, s44
    s_min_u32 s41, s41, s53
    s_add_u32 m0, s47, 0
    s_nop 0
    buffer_load_dwordx4 v1, s[20:23], s41 offen lds
    v_mfma_f32_32x32x16_bf16 v[96:111], v[12:15], v[32:35], v[96:111]
    ds_read_b64_tr_b16 v[12:13], v67 offset:0
    ds_read_b64_tr_b16 v[14:15], v67 offset:1536
    v_lshlrev_b32 v44, 16, v54
    v_and_b32 v45, s52, v54
    v_lshlrev_b32 v46, 16, v55
    v_and_b32 v47, s52, v55
    v_mfma_f32_32x32x16_bf16 v[112:127], v[16:19], v[32:35], v[112:127]
    ds_read_b64_tr_b16 v[16:17], v65 offset:256
    ds_read_b64_tr_b16 v[18:19], v65 offset:1792
    v_fma_f32 v44, v44, v78, v79
    v_fma_f32 v45, v45, v78, v79
    v_fma_f32 v46, v46, v78, v79
    v_fma_f32 v47, v47, v78, v79
    s_add_u32 m0, s47, 1024
    s_nop 0
    buffer_load_dwordx4 v2, s[20:23], s41 offen lds
    v_mfma_f32_32x32x16_bf16 v[128:143], v[20:23], v[32:35], v[128:143]
    ds_read_b64_tr_b16 v[20:21], v67 offset:256
    ds_read_b64_tr_b16 v[22:23], v67 offset:1792
    v_cvt_pk_bf16_f32 v54, v44, v45
    v_cvt_pk_bf16_f32 v55, v46, v47
    v_mfma_f32_32x32x16_bf16 v[144:159], v[24:27], v[32:35], v[144:159]
    ds_read_b64_tr_b16 v[24:25], v65 offset:512
    ds_read_b64_tr_b16 v[26:27], v65 offset:2048
    ds_write_b128 v75, v[52:55]
    v_add_u32 v75, s51, v75
    s_add_u32 m0, s47, 2048
    s_nop 0
    buffer_load_dwordx4 v3, s[20:23], s41 offen lds
    s_add_u32 s69, s69, 1
    s_cmp_eq_u32 s69, 3
    s_cselect_b32 s69, 0, s69
    s_cmp_eq_u32 s69, 2
    s_cselect_b32 s50, 0xffff8000, s57
    s_waitcnt lgkmcnt(10)
    v_mfma_f32_32x32x16_bf16 v[80:95], v[56:59], v[36:39], v[80:95]
    ds_read_b128 v[32:35], v68
    v_add_u32 v68, s50, v68
    ds_read_b64_tr_b16 v[56:57], v65 offset:6144
    ds_read_b64_tr_b16 v[58:59], v65 offset:7680
    v_mfma_f32_32x32x16_bf16 v[96:111], v[60:63], v[36:39], v[96:111]
    ds_read_b64_tr_b16 v[60:61], v67 offset:6144
    ds_read_b64_tr_b16 v[62:63], v67 offset:7680
    v_mfma_f32_32x32x16_bf16 v[112:127], v[176:179], v[36:39], v[112:127]
    ds_read_b64_tr_b16 v[176:177], v65 offset:6400
    ds_read_b64_tr_b16 v[178:179], v65 offset:7936
    v_mfma_f32_32x32x16_bf16 v[128:143], v[180:183], v[36:39], v[128:143]
    ds_read_b64_tr_b16 v[180:181], v67 offset:6400
    ds_read_b64_tr_b16 v[182:183], v67 offset:7936
    v_mfma_f32_32x32x16_bf16 v[144:159], v[184:187], v[36:39], v[144:159]
    ds_read_b64_tr_b16 v[184:185], v65 offset:6656
    ds_read_b64_tr_b16 v[186:187], v65 offset:8192
    v_xor_b32 v64, 0xc000, v64
    v_xor_b32 v65, 0xc000, v65
    v_xor_b32 v66, 0xc000, v66
    v_xor_b32 v67, 0xc000, v67
    s_cmp_eq_u32 s69, 0
    s_cselect_b32 s51, 0xffff8000, s57
    s_add_u32 s68, s68, 8
    s_min_u32 s68, s68, 72
    s_add_u32 s49, s49, 1
    s_cmp_lt_u32 s49, 10
    s_cbranch_scc1 K1LOOP_1002
    s_lshl_b32 s62, s36, 2
    s_add_u32 s62, s62, s39
    v_lshlrev_b32 v72, 4, v0
    s_waitcnt lgkmcnt(0)
    s_and_b32 s54, s37, 1
    s_lshl_b32 s54, s54, 4
    s_lshl_b32 s55, s40, 3
    s_add_u32 s54, s54, s55
    v_lshrrev_b32 v8, 5, v0
    v_and_b32 v9, 31, v0
    s_lshl_b32 s55, s54, 6
    s_add_u32 s55, s55, s62
    s_cmp_lt_u32 s37, 2
    s_cbranch_scc0 K1_EPK
    s_add_u32 s32, s16, 0x0
    s_addc_u32 s33, s17, 0
    s_mov_b32 s34, 0x300000
    s_mov_b32 s35, 0x00020000
    v_mov_b32 v6, 0x3ea52b5c
    s_mov_b32 s56, 393216
    v_mul_lo_u32 v10, v8, s56
    v_lshl_add_u32 v10, v9, 4, v10
    s_mul_i32 s55, s55, 1536
    v_pk_mul_f32 v[80:81], v[80:81], v[6:7] op_sel_hi:[1,0]
    v_pk_mul_f32 v[82:83], v[82:83], v[6:7] op_sel_hi:[1,0]
    v_pk_mul_f32 v[84:85], v[84:85], v[6:7] op_sel_hi:[1,0]
    v_pk_mul_f32 v[86:87], v[86:87], v[6:7] op_sel_hi:[1,0]
    v_pk_mul_f32 v[88:89], v[88:89], v[6:7] op_sel_hi:[1,0]
    v_pk_mul_f32 v[90:91], v[90:91], v[6:7] op_sel_hi:[1,0]
    v_pk_mul_f32 v[92:93], v[92:93], v[6:7] op_sel_hi:[1,0]
    v_pk_mul_f32 v[94:95], v[94:95], v[6:7] op_sel_hi:[1,0]
    v_pk_mul_f32 v[96:97], v[96:97], v[6:7] op_sel_hi:[1,0]
    v_pk_mul_f32 v[98:99], v[98:99], v[6:7] op_sel_hi:[1,0]
    v_cvt_pk_bf16_f32 v12, v80, v81
    v_cvt_pk_bf16_f32 v13, v82, v83
    v_cvt_pk_bf16_f32 v14, v84, v85
    v_cvt_pk_bf16_f32 v15, v86, v87
    v_cvt_pk_bf16_f32 v16, v88, v89
    v_cvt_pk_bf16_f32 v17, v90, v91
    v_cvt_pk_bf16_f32 v18, v92, v93
    v_cvt_pk_bf16_f32 v19, v94, v95
    v_cvt_pk_bf16_f32 v20, v96, v97
    v_cvt_pk_bf16_f32 v21, v98, v99
    v_mul_f32 v22, v80, v80
    v_fmac_f32 v22, v81, v81
    v_fmac_f32 v22, v82, v82
    v_fmac_f32 v22, v83, v83
    v_fmac_f32 v22, v84, v84
    v_fmac_f32 v22, v85, v85
    v_fmac_f32 v22, v86, v86
    v_fmac_f32 v22, v87, v87
    v_fmac_f32 v22, v88, v88
    v_fmac_f32 v22, v89, v89
    v_fmac_f32 v22, v90, v90
    v_fmac_f32 v22, v91, v91
    v_fmac_f32 v22, v92, v92
    v_fmac_f32 v22, v93, v93
    v_fmac_f32 v22, v94, v94
    v_fmac_f32 v22, v95, v95
    v_fmac_f32 v22, v96, v96
    v_fmac_f32 v22, v97, v97
    v_fmac_f32 v22, v98, v98
    v_fmac_f32 v22, v99, v99
    v_mov_b32 v23, 0
    v_sqrt_f32 v22, v22
    buffer_store_dwordx4 v[12:15], v10, s[32:35], s55 offen sc1
    buffer_store_dwordx4 v[16:19], v10, s[32:35], s55 offen offset:512 sc1
    buffer_store_dwordx4 v[20:23], v10, s[32:35], s55 offen offset:1024 sc1
    s_add_u32 s55, s55, 98304
    v_pk_mul_f32 v[100:101], v[100:101], v[6:7] op_sel_hi:[1,0]
    v_pk_mul_f32 v[102:103], v[102:103], v[6:7] op_sel_hi:[1,0]
    v_pk_mul_f32 v[104:105], v[104:105], v[6:7] op_sel_hi:[1,0]
    v_pk_mul_f32 v[106:107], v[106:107], v[6:7] op_sel_hi:[1,0]
    v_pk_mul_f32 v[108:109], v[108:109], v[6:7] op_sel_hi:[1,0]
    v_pk_mul_f32 v[110:111], v[110:111], v[6:7] op_sel_hi:[1,0]
    v_pk_mul_f32 v[112:113], v[112:113], v[6:7] op_sel_hi:[1,0]
    v_pk_mul_f32 v[114:115], v[114:115], v[6:7] op_sel_hi:[1,0]
    v_pk_mul_f32 v[116:117], v[116:117], v[6:7] op_sel_hi:[1,0]
    v_pk_mul_f32 v[118:119], v[118:119], v[6:7] op_sel_hi:[1,0]
    v_cvt_pk_bf16_f32 v24, v100, v101
    v_cvt_pk_bf16_f32 v25, v102, v103
    v_cvt_pk_bf16_f32 v26, v104, v105
    v_cvt_pk_bf16_f32 v27, v106, v107
    v_cvt_pk_bf16_f32 v28, v108, v109
    v_cvt_pk_bf16_f32 v29, v110, v111
    v_cvt_pk_bf16_f32 v30, v112, v113
    v_cvt_pk_bf16_f32 v31, v114, v115
    v_cvt_pk_bf16_f32 v32, v116, v117
    v_cvt_pk_bf16_f32 v33, v118, v119
    v_mul_f32 v34, v100, v100
    v_fmac_f32 v34, v101, v101
    v_fmac_f32 v34, v102, v102
    v_fmac_f32 v34, v103, v103
    v_fmac_f32 v34, v104, v104
    v_fmac_f32 v34, v105, v105
    v_fmac_f32 v34, v106, v106
    v_fmac_f32 v34, v107, v107
    v_fmac_f32 v34, v108, v108
    v_fmac_f32 v34, v109, v109
    v_fmac_f32 v34, v110, v110
    v_fmac_f32 v34, v111, v111
    v_fmac_f32 v34, v112, v112
    v_fmac_f32 v34, v113, v113
    v_fmac_f32 v34, v114, v114
    v_fmac_f32 v34, v115, v115
    v_fmac_f32 v34, v116, v116
    v_fmac_f32 v34, v117, v117
    v_fmac_f32 v34, v118, v118
    v_fmac_f32 v34, v119, v119
    v_mov_b32 v35, 0
    v_sqrt_f32 v34, v34
    buffer_store_dwordx4 v[24:27], v10, s[32:35], s55 offen sc1
    buffer_store_dwordx4 v[28:31], v10, s[32:35], s55 offen offset:512 sc1
    buffer_store_dwordx4 v[32:35], v10, s[32:35], s55 offen offset:1024 sc1
    s_add_u32 s55, s55, 98304
    v_pk_mul_f32 v[120:121], v[120:121], v[6:7] op_sel_hi:[1,0]
    v_pk_mul_f32 v[122:123], v[122:123], v[6:7] op_sel_hi:[1,0]
    v_pk_mul_f32 v[124:125], v[124:125], v[6:7] op_sel_hi:[1,0]
    v_pk_mul_f32 v[126:127], v[126:127], v[6:7] op_sel_hi:[1,0]
    v_pk_mul_f32 v[128:129], v[128:129], v[6:7] op_sel_hi:[1,0]
    v_pk_mul_f32 v[130:131], v[130:131], v[6:7] op_sel_hi:[1,0]
    v_pk_mul_f32 v[132:133], v[132:133], v[6:7] op_sel_hi:[1,0]
    v_pk_mul_f32 v[134:135], v[134:135], v[6:7] op_sel_hi:[1,0]
    v_pk_mul_f32 v[136:137], v[136:137], v[6:7] op_sel_hi:[1,0]
    v_pk_mul_f32 v[138:139], v[138:139], v[6:7] op_sel_hi:[1,0]
    v_cvt_pk_bf16_f32 v12, v120, v121
    v_cvt_pk_bf16_f32 v13, v122, v123
    v_cvt_pk_bf16_f32 v14, v124, v125
    v_cvt_pk_bf16_f32 v15, v126, v127
    v_cvt_pk_bf16_f32 v16, v128, v129
    v_cvt_pk_bf16_f32 v17, v130, v131
    v_cvt_pk_bf16_f32 v18, v132, v133
    v_cvt_pk_bf16_f32 v19, v134, v135
    v_cvt_pk_bf16_f32 v20, v136, v137
    v_cvt_pk_bf16_f32 v21, v138, v139
    v_mul_f32 v22, v120, v120
    v_fmac_f32 v22, v121, v121
    v_fmac_f32 v22, v122, v122
    v_fmac_f32 v22, v123, v123
    v_fmac_f32 v22, v124, v124
    v_fmac_f32 v22, v125, v125
    v_fmac_f32 v22, v126, v126
    v_fmac_f32 v22, v127, v127
    v_fmac_f32 v22, v128, v128
    v_fmac_f32 v22, v129, v129
    v_fmac_f32 v22, v130, v130
    v_fmac_f32 v22, v131, v131
    v_fmac_f32 v22, v132, v132
    v_fmac_f32 v22, v133, v133
    v_fmac_f32 v22, v134, v134
    v_fmac_f32 v22, v135, v135
    v_fmac_f32 v22, v136, v136
    v_fmac_f32 v22, v137, v137
    v_fmac_f32 v22, v138, v138
    v_fmac_f32 v22, v139, v139
    v_mov_b32 v23, 0
    v_sqrt_f32 v22, v22
    buffer_store_dwordx4 v[12:15], v10, s[32:35], s55 offen sc1
    buffer_store_dwordx4 v[16:19], v10, s[32:35], s55 offen offset:512 sc1
    buffer_store_dwordx4 v[20:23], v10, s[32:35], s55 offen offset:1024 sc1
    s_add_u32 s55, s55, 98304
    v_pk_mul_f32 v[140:141], v[140:141], v[6:7] op_sel_hi:[1,0]
    v_pk_mul_f32 v[142:143], v[142:143], v[6:7] op_sel_hi:[1,0]
    v_pk_mul_f32 v[144:145], v[144:145], v[6:7] op_sel_hi:[1,0]
    v_pk_mul_f32 v[146:147], v[146:147], v[6:7] op_sel_hi:[1,0]
    v_pk_mul_f32 v[148:149], v[148:149], v[6:7] op_sel_hi:[1,0]
    v_pk_mul_f32 v[150:151], v[150:151], v[6:7] op_sel_hi:[1,0]
    v_pk_mul_f32 v[152:153], v[152:153], v[6:7] op_sel_hi:[1,0]
    v_pk_mul_f32 v[154:155], v[154:155], v[6:7] op_sel_hi:[1,0]
    v_pk_mul_f32 v[156:157], v[156:157], v[6:7] op_sel_hi:[1,0]
    v_pk_mul_f32 v[158:159], v[158:159], v[6:7] op_sel_hi:[1,0]
    v_cvt_pk_bf16_f32 v24, v140, v141
    v_cvt_pk_bf16_f32 v25, v142, v143
    v_cvt_pk_bf16_f32 v26, v144, v145
    v_cvt_pk_bf16_f32 v27, v146, v147
    v_cvt_pk_bf16_f32 v28, v148, v149
    v_cvt_pk_bf16_f32 v29, v150, v151
    v_cvt_pk_bf16_f32 v30, v152, v153
    v_cvt_pk_bf16_f32 v31, v154, v155
    v_cvt_pk_bf16_f32 v32, v156, v157
    v_cvt_pk_bf16_f32 v33, v158, v159
    v_mul_f32 v34, v140, v140
    v_fmac_f32 v34, v141, v141
    v_fmac_f32 v34, v142, v142
    v_fmac_f32 v34, v143, v143
    v_fmac_f32 v34, v144, v144
    v_fmac_f32 v34, v145, v145
    v_fmac_f32 v34, v146, v146
    v_fmac_f32 v34, v147, v147
    v_fmac_f32 v34, v148, v148
    v_fmac_f32 v34, v149, v149
    v_fmac_f32 v34, v150, v150
    v_fmac_f32 v34, v151, v151
    v_fmac_f32 v34, v152, v152
    v_fmac_f32 v34, v153, v153
    v_fmac_f32 v34, v154, v154
    v_fmac_f32 v34, v155, v155
    v_fmac_f32 v34, v156, v156
    v_fmac_f32 v34, v157, v157
    v_fmac_f32 v34, v158, v158
    v_fmac_f32 v34, v159, v159
    v_mov_b32 v35, 0
    v_sqrt_f32 v34, v34
    buffer_store_dwordx4 v[24:27], v10, s[32:35], s55 offen sc1
    buffer_store_dwordx4 v[28:31], v10, s[32:35], s55 offen offset:512 sc1
    buffer_store_dwordx4 v[32:35], v10, s[32:35], s55 offen offset:1024 sc1
    s_add_u32 s55, s55, 98304
    s_branch K1_FIN
K1_EPK:
    s_add_u32 s32, s16, 0x300000
    s_addc_u32 s33, s17, 0
    s_mov_b32 s34, 0x520000
    s_mov_b32 s35, 0x00020000
    s_add_u32 s64, s16, 0x8f0000
    s_addc_u32 s65, s17, 0
    s_mov_b32 s66, 0x2000
    s_mov_b32 s67, 0x00020000
    s_mov_b32 s56, 671744
    v_mul_lo_u32 v10, v8, s56
    v_lshl_add_u32 v11, v9, 3, v10
    v_lshl_add_u32 v10, v9, 4, v10
    v_lshlrev_b32 v36, 10, v8
    s_lshl_b32 s57, s55, 2
    s_mul_i32 s55, s55, 2624
    v_cvt_pk_bf16_f32 v12, v80, v81
    v_cvt_pk_bf16_f32 v13, v82, v83
    v_cvt_pk_bf16_f32 v14, v84, v85
    v_cvt_pk_bf16_f32 v15, v86, v87
    v_cvt_pk_bf16_f32 v16, v88, v89
    v_cvt_pk_bf16_f32 v17, v90, v91
    v_cvt_pk_bf16_f32 v18, v92, v93
    v_cvt_pk_bf16_f32 v19, v94, v95
    v_cvt_pk_bf16_f32 v20, v96, v97
    v_cvt_pk_bf16_f32 v21, v98, v99
    v_mul_f32 v22, v80, v80
    v_fmac_f32 v22, v81, v81
    v_fmac_f32 v22, v82, v82
    v_fmac_f32 v22, v83, v83
    v_fmac_f32 v22, v84, v84
    v_fmac_f32 v22, v85, v85
    v_fmac_f32 v22, v86, v86
    v_fmac_f32 v22, v87, v87
    v_fmac_f32 v22, v88, v88
    v_fmac_f32 v22, v89, v89
    v_fmac_f32 v22, v90, v90
    v_fmac_f32 v22, v91, v91
    v_fmac_f32 v22, v92, v92
    v_fmac_f32 v22, v93, v93
    v_fmac_f32 v22, v94, v94
    v_fmac_f32 v22, v95, v95
    v_fmac_f32 v22, v96, v96
    v_fmac_f32 v22, v97, v97
    v_fmac_f32 v22, v98, v98
    v_fmac_f32 v22, v99, v99
    buffer_store_dwordx4 v[12:15], v10, s[32:35], s55 offen sc1
    buffer_store_dwordx4 v[16:19], v10, s[32:35], s55 offen offset:512 sc1
    buffer_store_dwordx2 v[20:21], v11, s[32:35], s55 offen offset:1024 sc1
    s_nop 1
    v_max_f32_dpp v22, v22, v22 row_ror:1 row_mask:0xf bank_mask:0xf
    s_nop 1
    v_max_f32_dpp v22, v22, v22 row_ror:2 row_mask:0xf bank_mask:0xf
    s_nop 1
    v_max_f32_dpp v22, v22, v22 row_ror:4 row_mask:0xf bank_mask:0xf
    s_nop 1
    v_max_f32_dpp v22, v22, v22 row_ror:8 row_mask:0xf bank_mask:0xf
    v_mov_b32 v23, v22
    s_nop 1
    v_permlane16_swap_b32 v23, v22
    s_nop 1
    v_max_f32 v22, v22, v23
    buffer_store_dword v22, v36, s[64:67], s57 offen sc1
    s_add_u32 s55, s55, 167936
    s_add_u32 s57, s57, 256
    v_cvt_pk_bf16_f32 v24, v100, v101
    v_cvt_pk_bf16_f32 v25, v102, v103
    v_cvt_pk_bf16_f32 v26, v104, v105
    v_cvt_pk_bf16_f32 v27, v106, v107
    v_cvt_pk_bf16_f32 v28, v108, v109
    v_cvt_pk_bf16_f32 v29, v110, v111
    v_cvt_pk_bf16_f32 v30, v112, v113
    v_cvt_pk_bf16_f32 v31, v114, v115
    v_cvt_pk_bf16_f32 v32, v116, v117
    v_cvt_pk_bf16_f32 v33, v118, v119
    v_mul_f32 v34, v100, v100
    v_fmac_f32 v34, v101, v101
    v_fmac_f32 v34, v102, v102
    v_fmac_f32 v34, v103, v103
    v_fmac_f32 v34, v104, v104
    v_fmac_f32 v34, v105, v105
    v_fmac_f32 v34, v106, v106
    v_fmac_f32 v34, v107, v107
    v_fmac_f32 v34, v108, v108
    v_fmac_f32 v34, v109, v109
    v_fmac_f32 v34, v110, v110
    v_fmac_f32 v34, v111, v111
    v_fmac_f32 v34, v112, v112
    v_fmac_f32 v34, v113, v113
    v_fmac_f32 v34, v114, v114
    v_fmac_f32 v34, v115, v115
    v_fmac_f32 v34, v116, v116
    v_fmac_f32 v34, v117, v117
    v_fmac_f32 v34, v118, v118
    v_fmac_f32 v34, v119, v119
    buffer_store_dwordx4 v[24:27], v10, s[32:35], s55 offen sc1
    buffer_store_dwordx4 v[28:31], v10, s[32:35], s55 offen offset:512 sc1
    buffer_store_dwordx2 v[32:33], v11, s[32:35], s55 offen offset:1024 sc1
    s_nop 1
    v_max_f32_dpp v34, v34, v34 row_ror:1 row_mask:0xf bank_mask:0xf
    s_nop 1
    v_max_f32_dpp v34, v34, v34 row_ror:2 row_mask:0xf bank_mask:0xf
    s_nop 1
    v_max_f32_dpp v34, v34, v34 row_ror:4 row_mask:0xf bank_mask:0xf
    s_nop 1
    v_max_f32_dpp v34, v34, v34 row_ror:8 row_mask:0xf bank_mask:0xf
    v_mov_b32 v35, v34
    s_nop 1
    v_permlane16_swap_b32 v35, v34
    s_nop 1
    v_max_f32 v34, v34, v35
    buffer_store_dword v34, v36, s[64:67], s57 offen sc1
    s_add_u32 s55, s55, 167936
    s_add_u32 s57, s57, 256
    v_cvt_pk_bf16_f32 v12, v120, v121
    v_cvt_pk_bf16_f32 v13, v122, v123
    v_cvt_pk_bf16_f32 v14, v124, v125
    v_cvt_pk_bf16_f32 v15, v126, v127
    v_cvt_pk_bf16_f32 v16, v128, v129
    v_cvt_pk_bf16_f32 v17, v130, v131
    v_cvt_pk_bf16_f32 v18, v132, v133
    v_cvt_pk_bf16_f32 v19, v134, v135
    v_cvt_pk_bf16_f32 v20, v136, v137
    v_cvt_pk_bf16_f32 v21, v138, v139
    v_mul_f32 v22, v120, v120
    v_fmac_f32 v22, v121, v121
    v_fmac_f32 v22, v122, v122
    v_fmac_f32 v22, v123, v123
    v_fmac_f32 v22, v124, v124
    v_fmac_f32 v22, v125, v125
    v_fmac_f32 v22, v126, v126
    v_fmac_f32 v22, v127, v127
    v_fmac_f32 v22, v128, v128
    v_fmac_f32 v22, v129, v129
    v_fmac_f32 v22, v130, v130
    v_fmac_f32 v22, v131, v131
    v_fmac_f32 v22, v132, v132
    v_fmac_f32 v22, v133, v133
    v_fmac_f32 v22, v134, v134
    v_fmac_f32 v22, v135, v135
    v_fmac_f32 v22, v136, v136
    v_fmac_f32 v22, v137, v137
    v_fmac_f32 v22, v138, v138
    v_fmac_f32 v22, v139, v139
    buffer_store_dwordx4 v[12:15], v10, s[32:35], s55 offen sc1
    buffer_store_dwordx4 v[16:19], v10, s[32:35], s55 offen offset:512 sc1
    buffer_store_dwordx2 v[20:21], v11, s[32:35], s55 offen offset:1024 sc1
    s_nop 1
    v_max_f32_dpp v22, v22, v22 row_ror:1 row_mask:0xf bank_mask:0xf
    s_nop 1
    v_max_f32_dpp v22, v22, v22 row_ror:2 row_mask:0xf bank_mask:0xf
    s_nop 1
    v_max_f32_dpp v22, v22, v22 row_ror:4 row_mask:0xf bank_mask:0xf
    s_nop 1
    v_max_f32_dpp v22, v22, v22 row_ror:8 row_mask:0xf bank_mask:0xf
    v_mov_b32 v23, v22
    s_nop 1
    v_permlane16_swap_b32 v23, v22
    s_nop 1
    v_max_f32 v22, v22, v23
    buffer_store_dword v22, v36, s[64:67], s57 offen sc1
    s_add_u32 s55, s55, 167936
    s_add_u32 s57, s57, 256
    v_cvt_pk_bf16_f32 v24, v140, v141
    v_cvt_pk_bf16_f32 v25, v142, v143
    v_cvt_pk_bf16_f32 v26, v144, v145
    v_cvt_pk_bf16_f32 v27, v146, v147
    v_cvt_pk_bf16_f32 v28, v148, v149
    v_cvt_pk_bf16_f32 v29, v150, v151
    v_cvt_pk_bf16_f32 v30, v152, v153
    v_cvt_pk_bf16_f32 v31, v154, v155
    v_cvt_pk_bf16_f32 v32, v156, v157
    v_cvt_pk_bf16_f32 v33, v158, v159
    v_mul_f32 v34, v140, v140
    v_fmac_f32 v34, v141, v141
    v_fmac_f32 v34, v142, v142
    v_fmac_f32 v34, v143, v143
    v_fmac_f32 v34, v144, v144
    v_fmac_f32 v34, v145, v145
    v_fmac_f32 v34, v146, v146
    v_fmac_f32 v34, v147, v147
    v_fmac_f32 v34, v148, v148
    v_fmac_f32 v34, v149, v149
    v_fmac_f32 v34, v150, v150
    v_fmac_f32 v34, v151, v151
    v_fmac_f32 v34, v152, v152
    v_fmac_f32 v34, v153, v153
    v_fmac_f32 v34, v154, v154
    v_fmac_f32 v34, v155, v155
    v_fmac_f32 v34, v156, v156
    v_fmac_f32 v34, v157, v157
    v_fmac_f32 v34, v158, v158
    v_fmac_f32 v34, v159, v159
    buffer_store_dwordx4 v[24:27], v10, s[32:35], s55 offen sc1
    buffer_store_dwordx4 v[28:31], v10, s[32:35], s55 offen offset:512 sc1
    buffer_store_dwordx2 v[32:33], v11, s[32:35], s55 offen offset:1024 sc1
    s_nop 1
    v_max_f32_dpp v34, v34, v34 row_ror:1 row_mask:0xf bank_mask:0xf
    s_nop 1
    v_max_f32_dpp v34, v34, v34 row_ror:2 row_mask:0xf bank_mask:0xf
    s_nop 1
    v_max_f32_dpp v34, v34, v34 row_ror:4 row_mask:0xf bank_mask:0xf
    s_nop 1
    v_max_f32_dpp v34, v34, v34 row_ror:8 row_mask:0xf bank_mask:0xf
    v_mov_b32 v35, v34
    s_nop 1
    v_permlane16_swap_b32 v35, v34
    s_nop 1
    v_max_f32 v34, v34, v35
    buffer_store_dword v34, v36, s[64:67], s57 offen sc1
    s_add_u32 s55, s55, 167936
    s_add_u32 s57, s57, 256
    s_branch K1_FIN
K1_V:
    ds_read_b128 v[32:35], v68
    v_add_u32 v68, s50, v68
    ds_read_b64_tr_b16 v[8:9], v64 offset:0
    ds_read_b64_tr_b16 v[10:11], v64 offset:1536
    ds_read_b64_tr_b16 v[12:13], v64 offset:256
    ds_read_b64_tr_b16 v[14:15], v64 offset:1792
    ds_read_b64_tr_b16 v[16:17], v64 offset:512
    ds_read_b64_tr_b16 v[18:19], v64 offset:2048
    ds_read_b64_tr_b16 v[20:21], v64 offset:768
    ds_read_b64_tr_b16 v[22:23], v64 offset:2304
    ds_read_b64_tr_b16 v[24:25], v64 offset:1024
    ds_read_b64_tr_b16 v[26:27], v64 offset:2560
    ds_read_b64_tr_b16 v[56:57], v64 offset:6144
    ds_read_b64_tr_b16 v[58:59], v64 offset:7680
    ds_read_b64_tr_b16 v[60:61], v64 offset:6400
    ds_read_b64_tr_b16 v[62:63], v64 offset:7936
    ds_read_b64_tr_b16 v[176:177], v64 offset:6656
    ds_read_b64_tr_b16 v[178:179], v64 offset:8192
    ds_read_b64_tr_b16 v[180:181], v64 offset:6912
    ds_read_b64_tr_b16 v[182:183], v64 offset:8448
    ds_read_b64_tr_b16 v[184:185], v64 offset:7168
    ds_read_b64_tr_b16 v[186:187], v64 offset:8704
K1LOOP_1003:
    s_waitcnt vmcnt(3)
    s_barrier
    s_waitcnt lgkmcnt(10)
    v_mfma_f32_32x32x16_bf16 v[80:95], v[32:35], v[8:11], v[80:95]
    ds_read_b128 v[36:39], v69
    v_add_u32 v69, s50, v69
    ds_read_b64_tr_b16 v[8:9], v64 offset:24576
    ds_read_b64_tr_b16 v[10:11], v64 offset:26112
    s_add_u32 s47, s47, 24576
    s_cmp_ge_u32 s47, s66
    s_cselect_b32 s47, s59, s47
    s_add_u32 s41, s41, s44
    s_min_u32 s41, s41, s53
    s_add_u32 m0, s47, 0
    s_nop 0
    buffer_load_dwordx4 v1, s[20:23], s41 offen lds
    v_mfma_f32_32x32x16_bf16 v[96:111], v[32:35], v[12:15], v[96:111]
    ds_read_b64_tr_b16 v[12:13], v64 offset:24832
    ds_read_b64_tr_b16 v[14:15], v64 offset:26368
    s_set_gpr_idx_on s68, gpr_idx(SRC0)
    v_mov_b32 v48, v176
    v_mov_b32 v49, v177
    v_mov_b32 v50, v178
    v_mov_b32 v51, v179
    v_mov_b32 v52, v180
    v_mov_b32 v53, v181
    v_mov_b32 v54, v182
    v_mov_b32 v55, v183
    s_set_gpr_idx_off
    v_lshlrev_b32 v40, 16, v48
    v_and_b32 v41, s52, v48
    v_lshlrev_b32 v42, 16, v49
    v_and_b32 v43, s52, v49
    v_mfma_f32_32x32x16_bf16 v[112:127], v[32:35], v[16:19], v[112:127]
    ds_read_b64_tr_b16 v[16:17], v64 offset:25088
    ds_read_b64_tr_b16 v[18:19], v64 offset:26624
    s_add_u32 m0, s47, 1024
    s_nop 0
    buffer_load_dwordx4 v2, s[20:23], s41 offen lds
    v_fma_f32 v40, v40, v76, v77
    v_fma_f32 v41, v41, v76, v77
    v_fma_f32 v42, v42, v76, v77
    v_fma_f32 v43, v43, v76, v77
    v_mfma_f32_32x32x16_bf16 v[128:143], v[32:35], v[20:23], v[128:143]
    ds_read_b64_tr_b16 v[20:21], v64 offset:25344
    ds_read_b64_tr_b16 v[22:23], v64 offset:26880
    v_cvt_pk_bf16_f32 v48, v40, v41
    v_cvt_pk_bf16_f32 v49, v42, v43
    s_add_u32 m0, s47, 2048
    s_nop 0
    buffer_load_dwordx4 v3, s[20:23], s41 offen lds
    v_mfma_f32_32x32x16_bf16 v[144:159], v[32:35], v[24:27], v[144:159]
    ds_read_b64_tr_b16 v[24:25], v64 offset:25600
    ds_read_b64_tr_b16 v[26:27], v64 offset:27136
    v_lshlrev_b32 v44, 16, v50
    v_and_b32 v45, s52, v50
    v_lshlrev_b32 v46, 16, v51
    v_and_b32 v47, s52, v51
    v_fma_f32 v44, v44, v76, v77
    v_fma_f32 v45, v45, v76, v77
    v_fma_f32 v46, v46, v76, v77
    v_fma_f32 v47, v47, v76, v77
    s_waitcnt lgkmcnt(10)
    v_mfma_f32_32x32x16_bf16 v[80:95], v[36:39], v[56:59], v[80:95]
    ds_read_b128 v[32:35], v70
    v_add_u32 v70, s50, v70
    ds_read_b64_tr_b16 v[56:57], v64 offset:30720
    ds_read_b64_tr_b16 v[58:59], v64 offset:32256
    v_cvt_pk_bf16_f32 v50, v44, v45
    v_cvt_pk_bf16_f32 v51, v46, v47
    v_mfma_f32_32x32x16_bf16 v[96:111], v[36:39], v[60:63], v[96:111]
    ds_read_b64_tr_b16 v[60:61], v64 offset:30976
    ds_read_b64_tr_b16 v[62:63], v64 offset:32512
    ds_write_b128 v74, v[48:51]
    v_add_u32 v74, s51, v74
    v_mfma_f32_32x32x16_bf16 v[112:127], v[36:39], v[176:179], v[112:127]
    ds_read_b64_tr_b16 v[176:177], v64 offset:31232
    ds_read_b64_tr_b16 v[178:179], v64 offset:32768
    v_lshlrev_b32 v40, 16, v52
    v_and_b32 v41, s52, v52
    v_lshlrev_b32 v42, 16, v53
    v_and_b32 v43, s52, v53
    v_mfma_f32_32x32x16_bf16 v[128:143], v[36:39], v[180:183], v[128:143]
    ds_read_b64_tr_b16 v[180:181], v64 offset:31488
    ds_read_b64_tr_b16 v[182:183], v64 offset:33024
    v_fma_f32 v40, v40, v78, v79
    v_fma_f32 v41, v41, v78, v79
    v_fma_f32 v42, v42, v78, v79
    v_fma_f32 v43, v43, v78, v79
    v_mfma_f32_32x32x16_bf16 v[144:159], v[36:39], v[184:187], v[144:159]
    ds_read_b64_tr_b16 v[184:185], v64 offset:31744
    ds_read_b64_tr_b16 v[186:187], v64 offset:33280
    v_cvt_pk_bf16_f32 v52, v40, v41
    v_cvt_pk_bf16_f32 v53, v42, v43
    s_waitcnt vmcnt(3)
    s_barrier
    s_waitcnt lgkmcnt(10)
    v_mfma_f32_32x32x16_bf16 v[80:95], v[32:35], v[8:11], v[80:95]
    ds_read_b128 v[36:39], v71
    v_add_u32 v71, s50, v71
    ds_read_b64_tr_b16 v[8:9], v65 offset:0
    ds_read_b64_tr_b16 v[10:11], v65 offset:1536
    s_add_u32 s47, s47, 24576
    s_cmp_ge_u32 s47, s66
    s_cselect_b32 s47, s59, s47
    s_add_u32 s41, s41, s44
    s_min_u32 s41, s41, s53
    s_add_u32 m0, s47, 0
    s_nop 0
    buffer_load_dwordx4 v1, s[20:23], s41 offen lds
    v_mfma_f32_32x32x16_bf16 v[96:111], v[32:35], v[12:15], v[96:111]
    ds_read_b64_tr_b16 v[12:13], v65 offset:256
    ds_read_b64_tr_b16 v[14:15], v65 offset:1792
    v_lshlrev_b32 v44, 16, v54
    v_and_b32 v45, s52, v54
    v_lshlrev_b32 v46, 16, v55
    v_and_b32 v47, s52, v55
    v_mfma_f32_32x32x16_bf16 v[112:127], v[32:35], v[16:19], v[112:127]
    ds_read_b64_tr_b16 v[16:17], v65 offset:512
    ds_read_b64_tr_b16 v[18:19], v65 offset:2048
    v_fma_f32 v44, v44, v78, v79
    v_fma_f32 v45, v45, v78, v79
    v_fma_f32 v46, v46, v78, v79
    v_fma_f32 v47, v47, v78, v79
    s_add_u32 m0, s47, 1024
    s_nop 0
    buffer_load_dwordx4 v2, s[20:23], s41 offen lds
    v_mfma_f32_32x32x16_bf16 v[128:143], v[32:35], v[20:23], v[128:143]
    ds_read_b64_tr_b16 v[20:21], v65 offset:768
    ds_read_b64_tr_b16 v[22:23], v65 offset:2304
    v_cvt_pk_bf16_f32 v54, v44, v45
    v_cvt_pk_bf16_f32 v55, v46, v47
    v_mfma_f32_32x32x16_bf16 v[144:159], v[32:35], v[24:27], v[144:159]
    ds_read_b64_tr_b16 v[24:25], v65 offset:1024
    ds_read_b64_tr_b16 v[26:27], v65 offset:2560
    ds_write_b128 v75, v[52:55]
    v_add_u32 v75, s51, v75
    s_add_u32 m0, s47, 2048
    s_nop 0
    buffer_load_dwordx4 v3, s[20:23], s41 offen lds
    s_add_u32 s69, s69, 1
    s_cmp_eq_u32 s69, 3
    s_cselect_b32 s69, 0, s69
    s_cmp_eq_u32 s69, 2
    s_cselect_b32 s50, 0xffff8000, s57
    s_waitcnt lgkmcnt(10)
    v_mfma_f32_32x32x16_bf16 v[80:95], v[36:39], v[56:59], v[80:95]
    ds_read_b128 v[32:35], v68
    v_add_u32 v68, s50, v68
    ds_read_b64_tr_b16 v[56:57], v65 offset:6144
    ds_read_b64_tr_b16 v[58:59], v65 offset:7680
    v_mfma_f32_32x32x16_bf16 v[96:111], v[36:39], v[60:63], v[96:111]
    ds_read_b64_tr_b16 v[60:61], v65 offset:6400
    ds_read_b64_tr_b16 v[62:63], v65 offset:7936
    v_mfma_f32_32x32x16_bf16 v[112:127], v[36:39], v[176:179], v[112:127]
    ds_read_b64_tr_b16 v[176:177], v65 offset:6656
    ds_read_b64_tr_b16 v[178:179], v65 offset:8192
    v_mfma_f32_32x32x16_bf16 v[128:143], v[36:39], v[180:183], v[128:143]
    ds_read_b64_tr_b16 v[180:181], v65 offset:6912
    ds_read_b64_tr_b16 v[182:183], v65 offset:8448
    v_mfma_f32_32x32x16_bf16 v[144:159], v[36:39], v[184:187], v[144:159]
    ds_read_b64_tr_b16 v[184:185], v65 offset:7168
    ds_read_b64_tr_b16 v[186:187], v65 offset:8704
    v_xor_b32 v64, 0xc000, v64
    v_xor_b32 v65, 0xc000, v65
    s_cmp_eq_u32 s69, 0
    s_cselect_b32 s51, 0xffff8000, s57
    s_add_u32 s68, s68, 8
    s_min_u32 s68, s68, 72
    s_add_u32 s49, s49, 1
    s_cmp_lt_u32 s49, 10
    s_cbranch_scc1 K1LOOP_1003
    s_lshl_b32 s62, s36, 2
    s_add_u32 s62, s62, s39
    v_lshlrev_b32 v72, 4, v0
    s_waitcnt lgkmcnt(0)
    s_add_u32 s32, s16, 0x300000
    s_addc_u32 s33, s17, 0
    s_mov_b32 s34, 0x520000
    s_mov_b32 s35, 0x00020000
    v_lshrrev_b32 v8, 5, v0
    s_and_b32 s54, s37, 1
    s_mul_i32 s54, s54, 320
    s_mul_i32 s55, s40, 160
    s_add_u32 s54, s54, s55
    v_and_b32 v11, 31, v0
    v_add_u32 v11, s54, v11
    v_mul_u32_u24 v8, 336, v8
    s_movk_i32 s56, 3277
    s_mov_b32 s57, 167616
    v_add_u32 v50, 0, v11
    v_mul_lo_u32 v51, v50, s56
    v_lshrrev_b32 v51, 16, v51
    v_mul_lo_u32 v51, v51, s57
    v_lshl_add_u32 v51, v50, 4, v51
    v_add_u32 v44, v51, v8
    v_add_u32 v50, 32, v11
    v_mul_lo_u32 v51, v50, s56
    v_lshrrev_b32 v51, 16, v51
    v_mul_lo_u32 v51, v51, s57
    v_lshl_add_u32 v51, v50, 4, v51
    v_add_u32 v45, v51, v8
    v_add_u32 v50, 64, v11
    v_mul_lo_u32 v51, v50, s56
    v_lshrrev_b32 v51, 16, v51
    v_mul_lo_u32 v51, v51, s57
    v_lshl_add_u32 v51, v50, 4, v51
    v_add_u32 v46, v51, v8
    v_add_u32 v50, 96, v11
    v_mul_lo_u32 v51, v50, s56
    v_lshrrev_b32 v51, 16, v51
    v_mul_lo_u32 v51, v51, s57
    v_lshl_add_u32 v51, v50, 4, v51
    v_add_u32 v47, v51, v8
    v_add_u32 v50, 128, v11
    v_mul_lo_u32 v51, v50, s56
    v_lshrrev_b32 v51, 16, v51
    v_mul_lo_u32 v51, v51, s57
    v_lshl_add_u32 v51, v50, 4, v51
    v_add_u32 v48, v51, v8
    s_mul_i32 s56, s54, 3277
    s_lshr_b32 s56, s56, 16
    v_lshrrev_b32 v52, 2, v0
    v_add_u32 v52, s56, v52
    s_mov_b32 s57, 167936
    v_mul_lo_u32 v52, v52, s57
    v_and_b32 v53, 3, v0
    v_mul_u32_u24 v53, 336, v53
    v_add3_u32 v52, v52, v53, 32
    v_add_u32 v52, 288, v52
    v_bfrev_b32 v53, 1
    v_cmp_gt_u32 vcc, 32, v0
    v_mov_b32 v56, 0x3f803f80
    v_mov_b32 v57, 0x3f803f80
    v_mov_b32 v58, 0x3f803f80
    v_mov_b32 v59, 0x3f803f80
    v_cndmask_b32 v52, v53, v52, vcc
    s_mul_i32 s55, s62, 2624
    s_add_u32 s55, s55, 1280
    buffer_store_dwordx4 v[56:59], v52, s[32:35], s55 offen sc1
    v_cvt_pk_bf16_f32 v80, v80, v81
    v_cvt_pk_bf16_f32 v81, v82, v83
    v_cvt_pk_bf16_f32 v82, v84, v85
    v_cvt_pk_bf16_f32 v83, v86, v87
    v_cvt_pk_bf16_f32 v84, v88, v89
    v_cvt_pk_bf16_f32 v85, v90, v91
    v_cvt_pk_bf16_f32 v86, v92, v93
    v_cvt_pk_bf16_f32 v87, v94, v95
    buffer_store_dwordx4 v[80:83], v44, s[32:35], s55 offen offset:0 sc1
    buffer_store_dwordx4 v[84:87], v44, s[32:35], s55 offen offset:672 sc1
    v_cvt_pk_bf16_f32 v96, v96, v97
    v_cvt_pk_bf16_f32 v97, v98, v99
    v_cvt_pk_bf16_f32 v98, v100, v101
    v_cvt_pk_bf16_f32 v99, v102, v103
    v_cvt_pk_bf16_f32 v100, v104, v105
    v_cvt_pk_bf16_f32 v101, v106, v107
    v_cvt_pk_bf16_f32 v102, v108, v109
    v_cvt_pk_bf16_f32 v103, v110, v111
    buffer_store_dwordx4 v[96:99], v45, s[32:35], s55 offen offset:0 sc1
    buffer_store_dwordx4 v[100:103], v45, s[32:35], s55 offen offset:672 sc1
    v_cvt_pk_bf16_f32 v112, v112, v113
    v_cvt_pk_bf16_f32 v113, v114, v115
    v_cvt_pk_bf16_f32 v114, v116, v117
    v_cvt_pk_bf16_f32 v115, v118, v119
    v_cvt_pk_bf16_f32 v116, v120, v121
    v_cvt_pk_bf16_f32 v117, v122, v123
    v_cvt_pk_bf16_f32 v118, v124, v125
    v_cvt_pk_bf16_f32 v119, v126, v127
    buffer_store_dwordx4 v[112:115], v46, s[32:35], s55 offen offset:0 sc1
    buffer_store_dwordx4 v[116:119], v46, s[32:35], s55 offen offset:672 sc1
    v_cvt_pk_bf16_f32 v128, v128, v129
    v_cvt_pk_bf16_f32 v129, v130, v131
    v_cvt_pk_bf16_f32 v130, v132, v133
    v_cvt_pk_bf16_f32 v131, v134, v135
    v_cvt_pk_bf16_f32 v132, v136, v137
    v_cvt_pk_bf16_f32 v133, v138, v139
    v_cvt_pk_bf16_f32 v134, v140, v141
    v_cvt_pk_bf16_f32 v135, v142, v143
    buffer_store_dwordx4 v[128:131], v47, s[32:35], s55 offen offset:0 sc1
    buffer_store_dwordx4 v[132:135], v47, s[32:35], s55 offen offset:672 sc1
    v_cvt_pk_bf16_f32 v144, v144, v145
    v_cvt_pk_bf16_f32 v145, v146, v147
    v_cvt_pk_bf16_f32 v146, v148, v149
    v_cvt_pk_bf16_f32 v147, v150, v151
    v_cvt_pk_bf16_f32 v148, v152, v153
    v_cvt_pk_bf16_f32 v149, v154, v155
    v_cvt_pk_bf16_f32 v150, v156, v157
    v_cvt_pk_bf16_f32 v151, v158, v159
    buffer_store_dwordx4 v[144:147], v48, s[32:35], s55 offen offset:0 sc1
    buffer_store_dwordx4 v[148:151], v48, s[32:35], s55 offen offset:672 sc1
    s_branch K1_FIN
K1_AUX:
    s_mov_b32 s20, s14
    s_mov_b32 s21, s15
    s_mov_b32 s22, 0x21c000
    s_mov_b32 s23, 0x00020000
    s_mov_b32 s24, s8
    s_mov_b32 s25, s9
    s_mov_b32 s26, 0xc8000
    s_mov_b32 s27, 0x00020000
    s_add_u32 s32, s16, 0x1000000
    s_addc_u32 s33, s17, 0
    s_mov_b32 s34, 0x21c000
    s_mov_b32 s35, 0x00020000
    s_add_u32 s64, s16, 0x1300000
    s_addc_u32 s65, s17, 0
    s_mov_b32 s66, 0xc8000
    s_mov_b32 s67, 0x00020000
    s_lshl_b32 s54, s36, 3
    s_add_u32 s49, s54, s38
    v_bfe_u32 v8, v0, 2, 2
    v_mul_u32_u24 v8, 1280, v8
    v_lshrrev_b32 v9, 4, v0
    v_lshl_add_u32 v8, v9, 6, v8
    v_and_b32 v9, 3, v0
    v_lshl_add_u32 v1, v9, 4, v8
    v_bfe_u32 v8, v0, 2, 2
    v_lshlrev_b32 v8, 6, v8
    v_bfe_u32 v9, v0, 4, 1
    v_lshl_add_u32 v8, v9, 5, v8
    v_and_b32 v9, 3, v0
    v_lshl_add_u32 v8, v9, 3, v8
    s_lshl_b32 s47, s38, 13
    v_add_u32 v8, s47, v8
    v_lshrrev_b32 v9, 5, v0
    v_lshl_add_u32 v2, v9, 10, v8
    v_lshl_add_u32 v3, v9, 11, v8
    v_lshlrev_b32 v4, 4, v0
    s_add_u32 s28, s16, 0x1400000
    s_addc_u32 s29, s17, 0
    s_mov_b32 s30, 0x280000
    s_mov_b32 s31, 0x00020000
    s_mul_i32 s54, s49, 20480
    v_mov_b32 v8, -1
    v_mov_b32 v9, -1
    v_mov_b32 v10, -1
    v_mov_b32 v11, -1
    buffer_store_dwordx4 v[8:11], v4, s[28:31], s54 offen offset:0 sc1
    buffer_store_dwordx4 v[8:11], v4, s[28:31], s54 offen offset:1024 sc1
    buffer_store_dwordx4 v[8:11], v4, s[28:31], s54 offen offset:2048 sc1
    buffer_store_dwordx4 v[8:11], v4, s[28:31], s54 offen offset:3072 sc1
    s_add_u32 s54, s54, 4096
    buffer_store_dwordx4 v[8:11], v4, s[28:31], s54 offen offset:0 sc1
    buffer_store_dwordx4 v[8:11], v4, s[28:31], s54 offen offset:1024 sc1
    buffer_store_dwordx4 v[8:11], v4, s[28:31], s54 offen offset:2048 sc1
    buffer_store_dwordx4 v[8:11], v4, s[28:31], s54 offen offset:3072 sc1
    s_add_u32 s54, s54, 4096
    buffer_store_dwordx4 v[8:11], v4, s[28:31], s54 offen offset:0 sc1
    buffer_store_dwordx4 v[8:11], v4, s[28:31], s54 offen offset:1024 sc1
    buffer_store_dwordx4 v[8:11], v4, s[28:31], s54 offen offset:2048 sc1
    buffer_store_dwordx4 v[8:11], v4, s[28:31], s54 offen offset:3072 sc1
    s_add_u32 s54, s54, 4096
    buffer_store_dwordx4 v[8:11], v4, s[28:31], s54 offen offset:0 sc1
    buffer_store_dwordx4 v[8:11], v4, s[28:31], s54 offen offset:1024 sc1
    buffer_store_dwordx4 v[8:11], v4, s[28:31], s54 offen offset:2048 sc1
    buffer_store_dwordx4 v[8:11], v4, s[28:31], s54 offen offset:3072 sc1
    s_add_u32 s54, s54, 4096
    buffer_store_dwordx4 v[8:11], v4, s[28:31], s54 offen offset:0 sc1
    buffer_store_dwordx4 v[8:11], v4, s[28:31], s54 offen offset:1024 sc1
    buffer_store_dwordx4 v[8:11], v4, s[28:31], s54 offen offset:2048 sc1
    buffer_store_dwordx4 v[8:11], v4, s[28:31], s54 offen offset:3072 sc1
    s_add_u32 s54, s54, 4096
K1_AUXLOOP:
    s_cmp_ge_u32 s49, 370
    s_cbranch_scc1 K1_FIN
    s_cmp_ge_u32 s49, 270
    s_cbranch_scc1 K1_AUXWO
    s_mov_b32 s54, s49
    s_mul_i32 s55, s54, 13108
    s_lshr_b32 s55, s55, 16
    s_mul_i32 s56, s55, 5
    s_sub_u32 s56, s54, s56
    s_mul_i32 s41, s55, 40960
    s_lshl_b32 s57, s56, 8
    s_add_u32 s41, s41, s57
    s_add_u32 m0, s47, 0
    s_nop 0
    buffer_load_dwordx4 v1, s[20:23], s41 offen lds
    s_add_u32 s41, s41, 5120
    s_add_u32 m0, s47, 1024
    s_nop 0
    buffer_load_dwordx4 v1, s[20:23], s41 offen lds
    s_add_u32 s41, s41, 5120
    s_add_u32 m0, s47, 2048
    s_nop 0
    buffer_load_dwordx4 v1, s[20:23], s41 offen lds
    s_add_u32 s41, s41, 5120
    s_add_u32 m0, s47, 3072
    s_nop 0
    buffer_load_dwordx4 v1, s[20:23], s41 offen lds
    s_add_u32 s41, s41, 5120
    s_add_u32 m0, s47, 4096
    s_nop 0
    buffer_load_dwordx4 v1, s[20:23], s41 offen lds
    s_add_u32 s41, s41, 5120
    s_add_u32 m0, s47, 5120
    s_nop 0
    buffer_load_dwordx4 v1, s[20:23], s41 offen lds
    s_add_u32 s41, s41, 5120
    s_add_u32 m0, s47, 6144
    s_nop 0
    buffer_load_dwordx4 v1, s[20:23], s41 offen lds
    s_add_u32 s41, s41, 5120
    s_add_u32 m0, s47, 7168
    s_nop 0
    buffer_load_dwordx4 v1, s[20:23], s41 offen lds
    s_add_u32 s41, s41, 5120
    s_mul_i32 s42, s56, 442368
    s_lshl_b32 s57, s55, 11
    s_add_u32 s42, s42, s57
    s_waitcnt vmcnt(0)
    ds_read_b64_tr_b16 v[16:17], v2 offset:0
    ds_read_b64_tr_b16 v[18:19], v2 offset:2048
    ds_read_b64_tr_b16 v[20:21], v2 offset:4096
    ds_read_b64_tr_b16 v[22:23], v2 offset:6144
    ds_read_b64_tr_b16 v[24:25], v2 offset:256
    ds_read_b64_tr_b16 v[26:27], v2 offset:2304
    ds_read_b64_tr_b16 v[28:29], v2 offset:4352
    ds_read_b64_tr_b16 v[30:31], v2 offset:6400
    ds_read_b64_tr_b16 v[32:33], v2 offset:512
    ds_read_b64_tr_b16 v[34:35], v2 offset:2560
    ds_read_b64_tr_b16 v[36:37], v2 offset:4608
    ds_read_b64_tr_b16 v[38:39], v2 offset:6656
    ds_read_b64_tr_b16 v[40:41], v2 offset:768
    ds_read_b64_tr_b16 v[42:43], v2 offset:2816
    ds_read_b64_tr_b16 v[44:45], v2 offset:4864
    ds_read_b64_tr_b16 v[46:47], v2 offset:6912
    s_waitcnt lgkmcnt(0)
    buffer_store_dwordx4 v[16:19], v4, s[32:35], s42 offen offset:0 sc1
    buffer_store_dwordx4 v[20:23], v4, s[32:35], s42 offen offset:1024 sc1
    s_add_u32 s42, s42, 110592
    buffer_store_dwordx4 v[24:27], v4, s[32:35], s42 offen offset:0 sc1
    buffer_store_dwordx4 v[28:31], v4, s[32:35], s42 offen offset:1024 sc1
    s_add_u32 s42, s42, 110592
    buffer_store_dwordx4 v[32:35], v4, s[32:35], s42 offen offset:0 sc1
    buffer_store_dwordx4 v[36:39], v4, s[32:35], s42 offen offset:1024 sc1
    s_add_u32 s42, s42, 110592
    buffer_store_dwordx4 v[40:43], v4, s[32:35], s42 offen offset:0 sc1
    buffer_store_dwordx4 v[44:47], v4, s[32:35], s42 offen offset:1024 sc1
    s_add_u32 s42, s42, 110592
    s_add_u32 s49, s49, 128
    s_waitcnt vmcnt(0)
    s_branch K1_AUXLOOP
K1_AUXWO:
    s_sub_u32 s54, s49, 270
    s_mul_i32 s55, s54, 13108
    s_lshr_b32 s55, s55, 16
    s_mul_i32 s56, s55, 5
    s_sub_u32 s56, s54, s56
    s_mul_i32 s41, s55, 40960
    s_lshl_b32 s57, s56, 8
    s_add_u32 s41, s41, s57
    s_add_u32 m0, s47, 0
    s_nop 0
    buffer_load_dwordx4 v1, s[24:27], s41 offen lds
    s_add_u32 s41, s41, 5120
    s_add_u32 m0, s47, 1024
    s_nop 0
    buffer_load_dwordx4 v1, s[24:27], s41 offen lds
    s_add_u32 s41, s41, 5120
    s_add_u32 m0, s47, 2048
    s_nop 0
    buffer_load_dwordx4 v1, s[24:27], s41 offen lds
    s_add_u32 s41, s41, 5120
    s_add_u32 m0, s47, 3072
    s_nop 0
    buffer_load_dwordx4 v1, s[24:27], s41 offen lds
    s_add_u32 s41, s41, 5120
    s_add_u32 m0, s47, 4096
    s_nop 0
    buffer_load_dwordx4 v1, s[24:27], s41 offen lds
    s_add_u32 s41, s41, 5120
    s_add_u32 m0, s47, 5120
    s_nop 0
    buffer_load_dwordx4 v1, s[24:27], s41 offen lds
    s_add_u32 s41, s41, 5120
    s_add_u32 m0, s47, 6144
    s_nop 0
    buffer_load_dwordx4 v1, s[24:27], s41 offen lds
    s_add_u32 s41, s41, 5120
    s_add_u32 m0, s47, 7168
    s_nop 0
    buffer_load_dwordx4 v1, s[24:27], s41 offen lds
    s_add_u32 s41, s41, 5120
    s_mul_i32 s42, s56, 163840
    s_lshl_b32 s57, s55, 11
    s_add_u32 s42, s42, s57
    s_waitcnt vmcnt(0)
    ds_read_b64_tr_b16 v[16:17], v3 offset:0
    ds_read_b64_tr_b16 v[18:19], v3 offset:1024
    ds_read_b64_tr_b16 v[20:21], v3 offset:4096
    ds_read_b64_tr_b16 v[22:23], v3 offset:5120
    ds_read_b64_tr_b16 v[24:25], v3 offset:256
    ds_read_b64_tr_b16 v[26:27], v3 offset:1280
    ds_read_b64_tr_b16 v[28:29], v3 offset:4352
    ds_read_b64_tr_b16 v[30:31], v3 offset:5376
    ds_read_b64_tr_b16 v[32:33], v3 offset:512
    ds_read_b64_tr_b16 v[34:35], v3 offset:1536
    ds_read_b64_tr_b16 v[36:37], v3 offset:4608
    ds_read_b64_tr_b16 v[38:39], v3 offset:5632
    ds_read_b64_tr_b16 v[40:41], v3 offset:768
    ds_read_b64_tr_b16 v[42:43], v3 offset:1792
    ds_read_b64_tr_b16 v[44:45], v3 offset:4864
    ds_read_b64_tr_b16 v[46:47], v3 offset:5888
    s_waitcnt lgkmcnt(0)
    buffer_store_dwordx4 v[16:19], v4, s[64:67], s42 offen offset:0 sc1
    buffer_store_dwordx4 v[20:23], v4, s[64:67], s42 offen offset:1024 sc1
    s_add_u32 s42, s42, 40960
    buffer_store_dwordx4 v[24:27], v4, s[64:67], s42 offen offset:0 sc1
    buffer_store_dwordx4 v[28:31], v4, s[64:67], s42 offen offset:1024 sc1
    s_add_u32 s42, s42, 40960
    buffer_store_dwordx4 v[32:35], v4, s[64:67], s42 offen offset:0 sc1
    buffer_store_dwordx4 v[36:39], v4, s[64:67], s42 offen offset:1024 sc1
    s_add_u32 s42, s42, 40960
    buffer_store_dwordx4 v[40:43], v4, s[64:67], s42 offen offset:0 sc1
    buffer_store_dwordx4 v[44:47], v4, s[64:67], s42 offen offset:1024 sc1
    s_add_u32 s42, s42, 40960
    s_add_u32 s49, s49, 128
    s_waitcnt vmcnt(0)
    s_branch K1_AUXLOOP
K1_FIN:
K1_END:
    s_endpgm
.globl mha_k2_kernel
.p2align 8
.type mha_k2_kernel,@function
mha_k2_kernel:
    s_cmp_ge_u32 s2, 256
    s_cbranch_scc1 K2_END
    s_load_dwordx2 s[4:5], s[0:1], 72
    s_load_dwordx2 s[62:63], s[0:1], 0
    s_load_dwordx2 s[68:69], s[0:1], 56
    v_lshrrev_b32 v1, 6, v0
    s_and_b32 s27, s2, 7
    s_lshr_b32 s28, s2, 3
    v_readfirstlane_b32 s24, v1
    s_and_b32 s39, s28, 3
    s_lshl_b32 s25, s27, 2
    s_add_u32 s25, s25, s39
    s_lshr_b32 s26, s2, 5
    s_lshl_b32 s38, s26, 3
    s_add_u32 s38, s38, s27
    v_mov_b32 v15, v0
    v_and_b32 v0, 63, v0
    v_lshlrev_b32 v1, 4, v0
    s_and_b32 s36, s24, 1
    s_lshr_b32 s37, s24, 1
    v_and_b32 v4, 31, v0
    v_lshrrev_b32 v5, 5, v0
    v_lshlrev_b32 v2, 3, v4
    v_add_u32 v2, 1024, v2
    v_mul_u32_u24 v3, 336, v5
    v_min_u32 v7, 20, v4
    v_lshl_add_u32 v3, v7, 4, v3
    v_add_u32 v3, 1280, v3
    s_lshl_b32 s27, s25, 6
    s_lshl_b32 s28, s37, 5
    s_add_u32 s28, s28, s27
    s_mul_i32 s31, s28, 2624
    s_add_u32 s32, s31, 81344
    s_mul_i32 s40, s27, 2624
    s_lshl_b32 s28, s26, 3
    s_lshl_b32 s29, s36, 2
    s_add_u32 s28, s28, s29
    s_add_u32 s28, s28, s27
    s_mul_i32 s28, s28, 1536
    v_lshlrev_b32 v6, 4, v4
    s_lshl_b32 s29, s25, 8
    v_lshlrev_b32 v7, 2, v0
    s_waitcnt lgkmcnt(0)
    s_add_u32 s20, s4, 0x8f0000
    s_addc_u32 s21, s5, 0
    s_mov_b32 s22, 0x2000
    s_mov_b32 s23, 0x00020000
    s_add_u32 s8, s4, 0x0
    s_addc_u32 s9, s5, 0
    s_mov_b32 s10, 0x300000
    s_mov_b32 s11, 0x00020000
    buffer_load_dword v8, v7, s[20:23], s29 offen
    buffer_load_dwordx4 v[80:83], v1, s[8:11], s28 offen
    buffer_load_dwordx4 v[84:87], v6, s[8:11], s28 offen offset:1024
    s_add_u32 s28, s28, 1536
    buffer_load_dwordx4 v[88:91], v1, s[8:11], s28 offen
    buffer_load_dwordx4 v[92:95], v6, s[8:11], s28 offen offset:1024
    s_add_u32 s28, s28, 1536
    buffer_load_dwordx4 v[96:99], v1, s[8:11], s28 offen
    buffer_load_dwordx4 v[100:103], v6, s[8:11], s28 offen offset:1024
    s_add_u32 s28, s28, 1536
    buffer_load_dwordx4 v[104:107], v1, s[8:11], s28 offen
    buffer_load_dwordx4 v[108:111], v6, s[8:11], s28 offen offset:1024
    s_add_u32 s28, s28, 1536
    s_add_u32 s12, s4, 0x300000
    s_addc_u32 s13, s5, 0
    s_mov_b32 s14, 0x522900
    s_mov_b32 s15, 0x00020000
    v_mov_b32 v158, 0x3f803f80
    v_mov_b32 v159, 0x3f80
    v_mov_b32 v174, 0x3f803f80
    v_mov_b32 v175, 0x3f80
    v_mov_b32 v190, 0x3f803f80
    v_mov_b32 v191, 0x3f80
    v_mov_b32 v206, 0x3f803f80
    v_mov_b32 v207, 0x3f80
    v_mov_b64 v[212:213], 0
    v_mov_b64 v[214:215], 0
    buffer_load_dwordx4 v[152:155], v1, s[12:15], s31 offen
    buffer_load_dwordx2 v[156:157], v2, s[12:15], s31 offen
    buffer_load_dwordx4 v[160:163], v3, s[12:15], s31 offen
    buffer_load_dwordx4 v[164:167], v3, s[12:15], s31 offen offset:672
    s_add_u32 s31, s31, 2624
    s_min_u32 s31, s31, s32
    s_add_u32 s44, s4, 0x900000
    s_addc_u32 s45, s5, 0
    s_mov_b32 s46, 0x6c2000
    s_mov_b32 s47, 0x00020000
    s_add_u32 s52, s4, 0x900000
    s_addc_u32 s53, s5, 0
    s_mov_b32 s54, 0x6c0000
    s_mov_b32 s55, 0x00020000
    s_add_u32 s48, s4, 0x1000000
    s_addc_u32 s49, s5, 0
    s_mov_b32 s50, 0x21e000
    s_mov_b32 s51, 0x00020000
    s_add_u32 s64, s4, 0x1000000
    s_addc_u32 s65, s5, 0
    s_mov_b32 s66, 0x21c000
    s_mov_b32 s67, 0x00020000
    s_mul_i32 s27, s24, 27
    s_mul_i32 s28, s38, 108
    s_add_u32 s28, s28, s27
    s_lshl_b32 s56, s28, 10
    s_mul_i32 s28, s39, 540
    s_add_u32 s28, s28, s27
    s_lshl_b32 s58, s28, 10
    v_add_u32 v10, 0x0, v1
    v_add_u32 v11, 0x1b000, v1
    v_add_u32 v12, 0x36000, v1
    v_add_u32 v13, 0x51000, v1
    v_add_u32 v14, 0x6c000, v1
    buffer_load_dwordx4 a[80:83], v1, s[44:47], s56 offen offset:0
    v_mov_b64 v[16:17], 0
    v_mov_b64 v[18:19], 0
    v_mov_b64 v[20:21], 0
    v_mov_b64 v[22:23], 0
    v_mov_b64 v[24:25], 0
    v_mov_b64 v[26:27], 0
    v_mov_b64 v[28:29], 0
    v_mov_b64 v[30:31], 0
    v_mov_b64 v[32:33], 0
    v_mov_b64 v[34:35], 0
    v_mov_b64 v[36:37], 0
    buffer_load_dwordx4 a[84:87], v10, s[48:51], s58 offen offset:0
    v_mov_b64 v[38:39], 0
    v_mov_b64 v[40:41], 0
    v_mov_b64 v[42:43], 0
    v_mov_b64 v[44:45], 0
    v_mov_b64 v[46:47], 0
    v_mov_b64 v[48:49], 0
    v_mov_b64 v[50:51], 0
    v_mov_b64 v[52:53], 0
    v_mov_b64 v[54:55], 0
    v_mov_b64 v[56:57], 0
    v_mov_b64 v[58:59], 0
    buffer_load_dwordx4 a[88:91], v11, s[48:51], s58 offen offset:0
    v_mov_b64 v[60:61], 0
    v_mov_b64 v[62:63], 0
    v_mov_b64 v[64:65], 0
    v_mov_b64 v[66:67], 0
    v_mov_b64 v[68:69], 0
    v_mov_b64 v[70:71], 0
    v_mov_b64 v[72:73], 0
    v_mov_b64 v[74:75], 0
    v_mov_b64 v[76:77], 0
    v_mov_b64 v[78:79], 0
    v_mov_b64 v[144:145], 0
    buffer_load_dwordx4 a[92:95], v12, s[48:51], s58 offen offset:0
    v_mov_b64 v[146:147], 0
    v_mov_b64 v[148:149], 0
    v_mov_b64 v[150:151], 0
    v_accvgpr_write_b32 a0, 0
    v_accvgpr_write_b32 a1, 0
    v_accvgpr_write_b32 a2, 0
    v_accvgpr_write_b32 a3, 0
    v_accvgpr_write_b32 a4, 0
    v_accvgpr_write_b32 a5, 0
    v_accvgpr_write_b32 a6, 0
    v_accvgpr_write_b32 a7, 0
    buffer_load_dwordx4 a[96:99], v13, s[48:51], s58 offen offset:0
    v_accvgpr_write_b32 a8, 0
    v_accvgpr_write_b32 a9, 0
    v_accvgpr_write_b32 a10, 0
    v_accvgpr_write_b32 a11, 0
    v_accvgpr_write_b32 a12, 0
    v_accvgpr_write_b32 a13, 0
    v_accvgpr_write_b32 a14, 0
    v_accvgpr_write_b32 a15, 0
    v_accvgpr_write_b32 a16, 0
    v_accvgpr_write_b32 a17, 0
    v_accvgpr_write_b32 a18, 0
    buffer_load_dwordx4 a[100:103], v14, s[48:51], s58 offen offset:0
    v_accvgpr_write_b32 a19, 0
    v_accvgpr_write_b32 a20, 0
    v_accvgpr_write_b32 a21, 0
    v_accvgpr_write_b32 a22, 0
    v_accvgpr_write_b32 a23, 0
    v_accvgpr_write_b32 a24, 0
    v_accvgpr_write_b32 a25, 0
    v_accvgpr_write_b32 a26, 0
    v_accvgpr_write_b32 a27, 0
    v_accvgpr_write_b32 a28, 0
    buffer_load_dwordx4 v[168:171], v1, s[12:15], s31 offen
    v_accvgpr_write_b32 a29, 0
    v_accvgpr_write_b32 a30, 0
    v_accvgpr_write_b32 a31, 0
    v_accvgpr_write_b32 a32, 0
    v_accvgpr_write_b32 a33, 0
    v_accvgpr_write_b32 a34, 0
    v_accvgpr_write_b32 a35, 0
    v_accvgpr_write_b32 a36, 0
    v_accvgpr_write_b32 a37, 0
    v_accvgpr_write_b32 a38, 0
    v_accvgpr_write_b32 a39, 0
    buffer_load_dwordx2 v[172:173], v2, s[12:15], s31 offen
    v_accvgpr_write_b32 a40, 0
    v_accvgpr_write_b32 a41, 0
    v_accvgpr_write_b32 a42, 0
    v_accvgpr_write_b32 a43, 0
    v_accvgpr_write_b32 a44, 0
    v_accvgpr_write_b32 a45, 0
    v_accvgpr_write_b32 a46, 0
    v_accvgpr_write_b32 a47, 0
    v_accvgpr_write_b32 a48, 0
    v_accvgpr_write_b32 a49, 0
    v_accvgpr_write_b32 a50, 0
    buffer_load_dwordx4 v[176:179], v3, s[12:15], s31 offen
    v_accvgpr_write_b32 a51, 0
    v_accvgpr_write_b32 a52, 0
    v_accvgpr_write_b32 a53, 0
    v_accvgpr_write_b32 a54, 0
    v_accvgpr_write_b32 a55, 0
    v_accvgpr_write_b32 a56, 0
    v_accvgpr_write_b32 a57, 0
    v_accvgpr_write_b32 a58, 0
    v_accvgpr_write_b32 a59, 0
    v_accvgpr_write_b32 a60, 0
    v_accvgpr_write_b32 a61, 0
    buffer_load_dwordx4 v[180:183], v3, s[12:15], s31 offen offset:672
    v_accvgpr_write_b32 a62, 0
    v_accvgpr_write_b32 a63, 0
    v_accvgpr_write_b32 a64, 0
    v_accvgpr_write_b32 a65, 0
    v_accvgpr_write_b32 a66, 0
    v_accvgpr_write_b32 a67, 0
    v_accvgpr_write_b32 a68, 0
    v_accvgpr_write_b32 a69, 0
    v_accvgpr_write_b32 a70, 0
    v_accvgpr_write_b32 a71, 0
    v_accvgpr_write_b32 a72, 0
    s_add_u32 s31, s31, 2624
    v_accvgpr_write_b32 a73, 0
    v_accvgpr_write_b32 a74, 0
    v_accvgpr_write_b32 a75, 0
    v_accvgpr_write_b32 a76, 0
    v_accvgpr_write_b32 a77, 0
    v_accvgpr_write_b32 a78, 0
    v_accvgpr_write_b32 a79, 0
    s_mul_i32 s27, s24, 6144
    s_add_u32 s27, s27, 83968
    v_add_u32 v216, s27, v1
    s_xor_b32 s28, s24, 2
    s_min_u32 s31, s31, s32
    s_mul_i32 s28, s28, 6144
    s_add_u32 s28, s28, 83968
    v_add_u32 v217, s28, v1
    s_movk_i32 s28, 3277
    v_bfrev_b32 v115, 1
    v_add_u32 v112, 0, v15
    v_mul_lo_u32 v113, v112, s28
    v_lshrrev_b32 v113, 16, v113
    v_mul_u32_u24 v114, 20, v113
    v_sub_u32 v114, v112, v114
    buffer_load_dwordx4 a[104:107], v1, s[44:47], s56 offen offset:1024
    v_mul_u32_u24 v218, 656, v113
    v_lshl_add_u32 v218, v114, 5, v218
    v_mul_u32_u24 v113, 1280, v113
    v_lshl_add_u32 v221, v114, 4, v113
    v_add_u32 v112, 256, v15
    v_mul_lo_u32 v113, v112, s28
    v_lshrrev_b32 v113, 16, v113
    v_mul_u32_u24 v114, 20, v113
    v_sub_u32 v114, v112, v114
    v_mul_u32_u24 v219, 656, v113
    v_lshl_add_u32 v219, v114, 5, v219
    buffer_load_dwordx4 a[108:111], v10, s[48:51], s58 offen offset:1024
    v_mul_u32_u24 v113, 1280, v113
    v_lshl_add_u32 v222, v114, 4, v113
    v_add_u32 v112, 512, v15
    v_mul_lo_u32 v113, v112, s28
    v_lshrrev_b32 v113, 16, v113
    v_mul_u32_u24 v114, 20, v113
    v_sub_u32 v114, v112, v114
    v_mul_u32_u24 v220, 656, v113
    v_lshl_add_u32 v220, v114, 5, v220
    v_mul_u32_u24 v113, 1280, v113
    v_lshl_add_u32 v223, v114, 4, v113
    buffer_load_dwordx4 a[112:115], v11, s[48:51], s58 offen offset:1024
    v_cmp_gt_u32 vcc, 640, v112
    s_nop 1
    v_cndmask_b32 v223, v115, v223, vcc
    v_cndmask_b32 v220, 0, v220, vcc
    s_mul_i32 s6, s38, 40960
    s_mul_i32 s28, s39, 320
    s_add_u32 s6, s6, s28
    s_mul_i32 s27, s25, 20
    v_lshlrev_b32 v112, 2, v5
    v_add_u32 v112, 0, v112
    v_add_u32 v112, s27, v112
    buffer_load_dwordx4 a[116:119], v12, s[48:51], s58 offen offset:1024
    v_lshrrev_b32 v113, 3, v112
    v_lshlrev_b32 v113, 9, v113
    v_and_b32 v114, 7, v112
    v_lshl_add_u32 v113, v114, 1, v113
    v_lshl_add_u32 v224, v4, 4, v113
    v_lshlrev_b32 v112, 2, v5
    v_add_u32 v112, 8, v112
    v_add_u32 v112, s27, v112
    v_lshrrev_b32 v113, 3, v112
    v_lshlrev_b32 v113, 9, v113
    v_and_b32 v114, 7, v112
    buffer_load_dwordx4 a[120:123], v13, s[48:51], s58 offen offset:1024
    v_lshl_add_u32 v113, v114, 1, v113
    v_lshl_add_u32 v225, v4, 4, v113
    v_mov_b32 v112, 16
    v_add_u32 v112, s27, v112
    v_lshrrev_b32 v113, 3, v112
    v_lshlrev_b32 v113, 9, v113
    v_and_b32 v114, 7, v112
    v_lshl_add_u32 v113, v114, 1, v113
    v_lshl_add_u32 v226, v4, 4, v113
    v_cmp_gt_u32 vcc, 32, v0
    s_lshl_b32 s28, s26, 3
    buffer_load_dwordx4 a[124:127], v14, s[48:51], s58 offen offset:1024
    s_lshl_b32 s29, s36, 2
    v_cndmask_b32 v226, v115, v226, vcc
    s_add_u32 s28, s28, s29
    s_lshl_b32 s29, s37, 1
    s_add_u32 s28, s28, s29
    s_mul_i32 s7, s28, 40960
    v_mul_u32_u24 v227, 656, v4
    v_lshl_add_u32 v227, v5, 4, v227
    s_mul_i32 s28, s24, 20992
    v_add_u32 v227, s28, v227
    s_waitcnt vmcnt(20)
    buffer_load_dwordx4 v[184:187], v1, s[12:15], s31 offen
    s_nop 1
    v_max_f32_dpp v8, v8, v8 row_ror:1 row_mask:0xf bank_mask:0xf
    s_nop 1
    v_max_f32_dpp v8, v8, v8 row_ror:2 row_mask:0xf bank_mask:0xf
    buffer_load_dwordx2 v[188:189], v2, s[12:15], s31 offen
    s_nop 1
    v_max_f32_dpp v8, v8, v8 row_ror:4 row_mask:0xf bank_mask:0xf
    s_nop 1
    v_max_f32_dpp v8, v8, v8 row_ror:8 row_mask:0xf bank_mask:0xf
    buffer_load_dwordx4 v[192:195], v3, s[12:15], s31 offen
    v_mov_b32 v9, v8
    s_nop 1
    v_permlane16_swap_b32 v9, v8
    s_nop 1
    buffer_load_dwordx4 v[196:199], v3, s[12:15], s31 offen offset:672
    v_max_f32 v8, v8, v9
    v_mov_b32 v9, v8
    s_nop 1
    v_permlane32_swap_b32 v9, v8
    s_add_u32 s31, s31, 2624
    s_nop 1
    v_max_f32 v8, v8, v9
    v_sqrt_f32 v8, v8
    s_nop 0
    s_min_u32 s31, s31, s32
    v_mul_f32 v8, 0x3f83d70a, v8
    s_mov_b64 s[60:61], 0
    v_mov_b32 v7, 0x42480000
    v_mul_f32 v9, v8, v86
    buffer_load_dwordx4 a[128:131], v1, s[44:47], s56 offen offset:2048
    v_cmp_nle_f32 vcc, v9, v7
    v_sub_f32 v9, 0, v9
    s_or_b64 s[60:61], s[60:61], vcc
    v_cvt_pk_bf16_f32 v86, v9, 0
    buffer_load_dwordx4 a[132:135], v10, s[48:51], s58 offen offset:2048
    v_mov_b32 v87, 0
    v_mul_f32 v9, v8, v94
    v_cmp_nle_f32 vcc, v9, v7
    v_sub_f32 v9, 0, v9
    buffer_load_dwordx4 a[136:139], v11, s[48:51], s58 offen offset:2048
    s_or_b64 s[60:61], s[60:61], vcc
    v_cvt_pk_bf16_f32 v94, v9, 0
    v_mov_b32 v95, 0
    v_mul_f32 v9, v8, v102
    buffer_load_dwordx4 a[140:143], v12, s[48:51], s58 offen offset:2048
    v_cmp_nle_f32 vcc, v9, v7
    v_sub_f32 v9, 0, v9
    s_or_b64 s[60:61], s[60:61], vcc
    v_cvt_pk_bf16_f32 v102, v9, 0
    buffer_load_dwordx4 a[144:147], v13, s[48:51], s58 offen offset:2048
    v_mov_b32 v103, 0
    v_mul_f32 v9, v8, v110
    v_cmp_nle_f32 vcc, v9, v7
    v_sub_f32 v9, 0, v9
    buffer_load_dwordx4 a[148:151], v14, s[48:51], s58 offen offset:2048
    s_or_b64 s[60:61], s[60:61], vcc
    v_cvt_pk_bf16_f32 v110, v9, 0
    v_mov_b32 v111, 0
    s_cmp_lg_u64 s[60:61], 0
    s_cbranch_scc1 K2_SLOW
K2_RUN:
    v_cmp_gt_u32 vcc, 32, v0
    s_nop 1
    v_cndmask_b32 v84, 0, v84, vcc
    v_cndmask_b32 v85, 0, v85, vcc
    v_cndmask_b32 v86, 0, v86, vcc
    v_cndmask_b32 v87, 0, v87, vcc
    v_cndmask_b32 v92, 0, v92, vcc
    v_cndmask_b32 v93, 0, v93, vcc
    v_cndmask_b32 v94, 0, v94, vcc
    v_cndmask_b32 v95, 0, v95, vcc
    v_cndmask_b32 v100, 0, v100, vcc
    v_cndmask_b32 v101, 0, v101, vcc
    v_cndmask_b32 v102, 0, v102, vcc
    v_cndmask_b32 v103, 0, v103, vcc
    v_cndmask_b32 v108, 0, v108, vcc
    v_cndmask_b32 v109, 0, v109, vcc
    v_cndmask_b32 v110, 0, v110, vcc
    v_cndmask_b32 v111, 0, v111, vcc
    s_waitcnt vmcnt(26)
    s_nop 0
    v_mfma_f32_32x32x16_bf16 v[112:127], v[152:155], v[80:83], 0
    v_mfma_f32_32x32x16_bf16 v[112:127], v[156:159], v[84:87], v[112:127]
    s_mov_b32 s33, 0
    s_nop 7
    s_nop 3
K2_LOOP:
    s_cmp_eq_u32 s33, 6
    s_cselect_b32 s54, 0, s46
    s_cselect_b32 s66, 0, s50
    v_mfma_f32_32x32x16_bf16 v[128:143], v[152:155], v[88:91], 0
    buffer_load_dwordx4 v[200:203], v1, s[12:15], s31 offen
    v_exp_f32 v112, v112
    v_exp_f32 v113, v113
    v_exp_f32 v114, v114
    v_exp_f32 v115, v115
    v_mfma_f32_32x32x16_bf16 v[64:79], v[212:215], v[148:151], v[64:79]
    buffer_load_dwordx2 v[204:205], v2, s[12:15], s31 offen
    v_exp_f32 v116, v116
    v_exp_f32 v117, v117
    v_exp_f32 v118, v118
    v_exp_f32 v119, v119
    v_mfma_f32_32x32x16_bf16 v[128:143], v[156:159], v[92:95], v[128:143]
    buffer_load_dwordx4 v[208:211], v3, s[12:15], s31 offen
    v_cvt_pk_bf16_f32 v144, v112, v113
    v_cvt_pk_bf16_f32 v145, v114, v115
    v_cvt_pk_bf16_f32 v146, v116, v117
    v_cvt_pk_bf16_f32 v147, v118, v119
    v_exp_f32 v120, v120
    v_exp_f32 v121, v121
    v_mfma_f32_32x32x16_bf16 v[16:31], v[160:163], v[144:147], v[16:31]
    buffer_load_dwordx4 v[212:215], v3, s[12:15], s31 offen offset:672
    v_exp_f32 v122, v122
    v_exp_f32 v123, v123
    v_exp_f32 v124, v124
    v_exp_f32 v125, v125
    s_waitcnt vmcnt(24)
    v_mfma_f32_32x32x16_bf16 a[0:15], a[84:87], a[80:83], a[0:15]
    s_add_u32 s31, s31, 2624
    v_exp_f32 v126, v126
    v_exp_f32 v127, v127
    v_cvt_pk_bf16_f32 v148, v120, v121
    v_cvt_pk_bf16_f32 v149, v122, v123
    v_cvt_pk_bf16_f32 v150, v124, v125
    v_cvt_pk_bf16_f32 v151, v126, v127
    v_mfma_f32_32x32x16_bf16 v[112:127], v[152:155], v[96:99], 0
    v_exp_f32 v128, v128
    v_exp_f32 v129, v129
    v_exp_f32 v130, v130
    v_exp_f32 v131, v131
    v_mfma_f32_32x32x16_bf16 v[16:31], v[164:167], v[148:151], v[16:31]
    buffer_load_dwordx4 a[152:155], v1, s[52:55], s56 offen offset:3072
    v_exp_f32 v132, v132
    v_exp_f32 v133, v133
    v_exp_f32 v134, v134
    v_exp_f32 v135, v135
    v_mfma_f32_32x32x16_bf16 v[112:127], v[156:159], v[100:103], v[112:127]
    buffer_load_dwordx4 a[156:159], v10, s[64:67], s58 offen offset:3072
    v_cvt_pk_bf16_f32 v144, v128, v129
    v_cvt_pk_bf16_f32 v145, v130, v131
    v_cvt_pk_bf16_f32 v146, v132, v133
    v_cvt_pk_bf16_f32 v147, v134, v135
    v_exp_f32 v136, v136
    v_exp_f32 v137, v137
    v_mfma_f32_32x32x16_bf16 v[32:47], v[160:163], v[144:147], v[32:47]
    v_exp_f32 v138, v138
    v_exp_f32 v139, v139
    v_exp_f32 v140, v140
    v_exp_f32 v141, v141
    v_mfma_f32_32x32x16_bf16 a[16:31], a[88:91], a[80:83], a[16:31]
    v_exp_f32 v142, v142
    v_exp_f32 v143, v143
    v_cvt_pk_bf16_f32 v148, v136, v137
    v_cvt_pk_bf16_f32 v149, v138, v139
    v_cvt_pk_bf16_f32 v150, v140, v141
    v_cvt_pk_bf16_f32 v151, v142, v143
    v_mfma_f32_32x32x16_bf16 v[128:143], v[152:155], v[104:107], 0
    v_exp_f32 v112, v112
    v_exp_f32 v113, v113
    v_exp_f32 v114, v114
    v_exp_f32 v115, v115
    v_mfma_f32_32x32x16_bf16 v[32:47], v[164:167], v[148:151], v[32:47]
    buffer_load_dwordx4 a[160:163], v11, s[64:67], s58 offen offset:3072
    v_exp_f32 v116, v116
    v_exp_f32 v117, v117
    v_exp_f32 v118, v118
    v_exp_f32 v119, v119
    v_mfma_f32_32x32x16_bf16 v[128:143], v[156:159], v[108:111], v[128:143]
    buffer_load_dwordx4 a[164:167], v12, s[64:67], s58 offen offset:3072
    v_cvt_pk_bf16_f32 v144, v112, v113
    v_cvt_pk_bf16_f32 v145, v114, v115
    v_cvt_pk_bf16_f32 v146, v116, v117
    v_cvt_pk_bf16_f32 v147, v118, v119
    v_exp_f32 v120, v120
    v_exp_f32 v121, v121
    v_mfma_f32_32x32x16_bf16 v[48:63], v[160:163], v[144:147], v[48:63]
    v_exp_f32 v122, v122
    v_exp_f32 v123, v123
    v_exp_f32 v124, v124
    v_exp_f32 v125, v125
    v_mfma_f32_32x32x16_bf16 a[32:47], a[92:95], a[80:83], a[32:47]
    v_exp_f32 v126, v126
    v_exp_f32 v127, v127
    v_cvt_pk_bf16_f32 v148, v120, v121
    v_cvt_pk_bf16_f32 v149, v122, v123
    v_cvt_pk_bf16_f32 v150, v124, v125
    v_cvt_pk_bf16_f32 v151, v126, v127
    s_waitcnt vmcnt(24)
    v_mfma_f32_32x32x16_bf16 v[112:127], v[168:171], v[80:83], 0
    v_exp_f32 v128, v128
    v_exp_f32 v129, v129
    v_exp_f32 v130, v130
    v_mfma_f32_32x32x16_bf16 v[48:63], v[164:167], v[148:151], v[48:63]
    buffer_load_dwordx4 a[168:171], v13, s[64:67], s58 offen offset:3072
    v_exp_f32 v131, v131
    v_exp_f32 v132, v132
    v_exp_f32 v133, v133
    v_mfma_f32_32x32x16_bf16 a[48:63], a[96:99], a[80:83], a[48:63]
    buffer_load_dwordx4 a[172:175], v14, s[64:67], s58 offen offset:3072
    v_exp_f32 v134, v134
    v_exp_f32 v135, v135
    v_cvt_pk_bf16_f32 v144, v128, v129
    v_cvt_pk_bf16_f32 v145, v130, v131
    v_mfma_f32_32x32x16_bf16 v[112:127], v[172:175], v[84:87], v[112:127]
    s_add_u32 s56, s56, 4096
    v_cvt_pk_bf16_f32 v146, v132, v133
    v_cvt_pk_bf16_f32 v147, v134, v135
    v_exp_f32 v136, v136
    v_exp_f32 v137, v137
    v_mfma_f32_32x32x16_bf16 v[64:79], v[160:163], v[144:147], v[64:79]
    s_add_u32 s58, s58, 4096
    v_exp_f32 v138, v138
    v_exp_f32 v139, v139
    v_exp_f32 v140, v140
    v_mfma_f32_32x32x16_bf16 a[64:79], a[100:103], a[80:83], a[64:79]
    v_exp_f32 v141, v141
    v_exp_f32 v142, v142
    v_exp_f32 v143, v143
    v_cvt_pk_bf16_f32 v148, v136, v137
    v_cvt_pk_bf16_f32 v149, v138, v139
    v_cvt_pk_bf16_f32 v150, v140, v141
    v_cvt_pk_bf16_f32 v151, v142, v143
    v_mfma_f32_32x32x16_bf16 v[128:143], v[168:171], v[88:91], 0
    buffer_load_dwordx4 v[152:155], v1, s[12:15], s31 offen
    v_exp_f32 v112, v112
    v_exp_f32 v113, v113
    v_exp_f32 v114, v114
    v_exp_f32 v115, v115
    v_mfma_f32_32x32x16_bf16 v[64:79], v[164:167], v[148:151], v[64:79]
    buffer_load_dwordx2 v[156:157], v2, s[12:15], s31 offen
    v_exp_f32 v116, v116
    v_exp_f32 v117, v117
    v_exp_f32 v118, v118
    v_exp_f32 v119, v119
    v_mfma_f32_32x32x16_bf16 v[128:143], v[172:175], v[92:95], v[128:143]
    buffer_load_dwordx4 v[160:163], v3, s[12:15], s31 offen
    v_cvt_pk_bf16_f32 v144, v112, v113
    v_cvt_pk_bf16_f32 v145, v114, v115
    v_cvt_pk_bf16_f32 v146, v116, v117
    v_cvt_pk_bf16_f32 v147, v118, v119
    v_exp_f32 v120, v120
    v_exp_f32 v121, v121
    v_mfma_f32_32x32x16_bf16 v[16:31], v[176:179], v[144:147], v[16:31]
    buffer_load_dwordx4 v[164:167], v3, s[12:15], s31 offen offset:672
    v_exp_f32 v122, v122
    v_exp_f32 v123, v123
    v_exp_f32 v124, v124
    v_exp_f32 v125, v125
    s_waitcnt vmcnt(24)
    v_mfma_f32_32x32x16_bf16 a[0:15], a[108:111], a[104:107], a[0:15]
    s_add_u32 s31, s31, 2624
    v_exp_f32 v126, v126
    v_exp_f32 v127, v127
    v_cvt_pk_bf16_f32 v148, v120, v121
    v_cvt_pk_bf16_f32 v149, v122, v123
    v_cvt_pk_bf16_f32 v150, v124, v125
    v_cvt_pk_bf16_f32 v151, v126, v127
    v_mfma_f32_32x32x16_bf16 v[112:127], v[168:171], v[96:99], 0
    v_exp_f32 v128, v128
    v_exp_f32 v129, v129
    v_exp_f32 v130, v130
    v_exp_f32 v131, v131
    v_mfma_f32_32x32x16_bf16 v[16:31], v[180:183], v[148:151], v[16:31]
    buffer_load_dwordx4 a[80:83], v1, s[52:55], s56 offen offset:0
    v_exp_f32 v132, v132
    v_exp_f32 v133, v133
    v_exp_f32 v134, v134
    v_exp_f32 v135, v135
    v_mfma_f32_32x32x16_bf16 v[112:127], v[172:175], v[100:103], v[112:127]
    buffer_load_dwordx4 a[84:87], v10, s[64:67], s58 offen offset:0
    v_cvt_pk_bf16_f32 v144, v128, v129
    v_cvt_pk_bf16_f32 v145, v130, v131
    v_cvt_pk_bf16_f32 v146, v132, v133
    v_cvt_pk_bf16_f32 v147, v134, v135
    v_exp_f32 v136, v136
    v_exp_f32 v137, v137
    v_mfma_f32_32x32x16_bf16 v[32:47], v[176:179], v[144:147], v[32:47]
    v_exp_f32 v138, v138
    v_exp_f32 v139, v139
    v_exp_f32 v140, v140
    v_exp_f32 v141, v141
    v_mfma_f32_32x32x16_bf16 a[16:31], a[112:115], a[104:107], a[16:31]
    v_exp_f32 v142, v142
    v_exp_f32 v143, v143
    v_cvt_pk_bf16_f32 v148, v136, v137
    v_cvt_pk_bf16_f32 v149, v138, v139
    v_cvt_pk_bf16_f32 v150, v140, v141
    v_cvt_pk_bf16_f32 v151, v142, v143
    v_mfma_f32_32x32x16_bf16 v[128:143], v[168:171], v[104:107], 0
    v_exp_f32 v112, v112
    v_exp_f32 v113, v113
    v_exp_f32 v114, v114
    v_exp_f32 v115, v115
    v_mfma_f32_32x32x16_bf16 v[32:47], v[180:183], v[148:151], v[32:47]
    buffer_load_dwordx4 a[88:91], v11, s[64:67], s58 offen offset:0
    v_exp_f32 v116, v116
    v_exp_f32 v117, v117
    v_exp_f32 v118, v118
    v_exp_f32 v119, v119
    v_mfma_f32_32x32x16_bf16 v[128:143], v[172:175], v[108:111], v[128:143]
    buffer_load_dwordx4 a[92:95], v12, s[64:67], s58 offen offset:0
    v_cvt_pk_bf16_f32 v144, v112, v113
    v_cvt_pk_bf16_f32 v145, v114, v115
    v_cvt_pk_bf16_f32 v146, v116, v117
    v_cvt_pk_bf16_f32 v147, v118, v119
    v_exp_f32 v120, v120
    v_exp_f32 v121, v121
    v_mfma_f32_32x32x16_bf16 v[48:63], v[176:179], v[144:147], v[48:63]
    v_exp_f32 v122, v122
    v_exp_f32 v123, v123
    v_exp_f32 v124, v124
    v_exp_f32 v125, v125
    v_mfma_f32_32x32x16_bf16 a[32:47], a[116:119], a[104:107], a[32:47]
    v_exp_f32 v126, v126
    v_exp_f32 v127, v127
    v_cvt_pk_bf16_f32 v148, v120, v121
    v_cvt_pk_bf16_f32 v149, v122, v123
    v_cvt_pk_bf16_f32 v150, v124, v125
    v_cvt_pk_bf16_f32 v151, v126, v127
    s_waitcnt vmcnt(24)
    v_mfma_f32_32x32x16_bf16 v[112:127], v[184:187], v[80:83], 0
    v_exp_f32 v128, v128
    v_exp_f32 v129, v129
    v_exp_f32 v130, v130
    v_mfma_f32_32x32x16_bf16 v[48:63], v[180:183], v[148:151], v[48:63]
    buffer_load_dwordx4 a[96:99], v13, s[64:67], s58 offen offset:0
    v_exp_f32 v131, v131
    v_exp_f32 v132, v132
    v_exp_f32 v133, v133
    v_mfma_f32_32x32x16_bf16 a[48:63], a[120:123], a[104:107], a[48:63]
    buffer_load_dwordx4 a[100:103], v14, s[64:67], s58 offen offset:0
    v_exp_f32 v134, v134
    v_exp_f32 v135, v135
    v_cvt_pk_bf16_f32 v144, v128, v129
    v_cvt_pk_bf16_f32 v145, v130, v131
    v_mfma_f32_32x32x16_bf16 v[112:127], v[188:191], v[84:87], v[112:127]
    v_cvt_pk_bf16_f32 v146, v132, v133
    v_cvt_pk_bf16_f32 v147, v134, v135
    v_exp_f32 v136, v136
    v_exp_f32 v137, v137
    v_mfma_f32_32x32x16_bf16 v[64:79], v[176:179], v[144:147], v[64:79]
    v_exp_f32 v138, v138
    v_exp_f32 v139, v139
    v_exp_f32 v140, v140
    v_mfma_f32_32x32x16_bf16 a[64:79], a[124:127], a[104:107], a[64:79]
    v_exp_f32 v141, v141
    v_exp_f32 v142, v142
    v_exp_f32 v143, v143
    v_cvt_pk_bf16_f32 v148, v136, v137
    v_cvt_pk_bf16_f32 v149, v138, v139
    v_cvt_pk_bf16_f32 v150, v140, v141
    v_cvt_pk_bf16_f32 v151, v142, v143
    v_mfma_f32_32x32x16_bf16 v[128:143], v[184:187], v[88:91], 0
    buffer_load_dwordx4 v[168:171], v1, s[12:15], s31 offen
    v_exp_f32 v112, v112
    v_exp_f32 v113, v113
    v_exp_f32 v114, v114
    v_exp_f32 v115, v115
    v_mfma_f32_32x32x16_bf16 v[64:79], v[180:183], v[148:151], v[64:79]
    buffer_load_dwordx2 v[172:173], v2, s[12:15], s31 offen
    v_exp_f32 v116, v116
    v_exp_f32 v117, v117
    v_exp_f32 v118, v118
    v_exp_f32 v119, v119
    v_mfma_f32_32x32x16_bf16 v[128:143], v[188:191], v[92:95], v[128:143]
    buffer_load_dwordx4 v[176:179], v3, s[12:15], s31 offen
    v_cvt_pk_bf16_f32 v144, v112, v113
    v_cvt_pk_bf16_f32 v145, v114, v115
    v_cvt_pk_bf16_f32 v146, v116, v117
    v_cvt_pk_bf16_f32 v147, v118, v119
    v_exp_f32 v120, v120
    v_exp_f32 v121, v121
    v_mfma_f32_32x32x16_bf16 v[16:31], v[192:195], v[144:147], v[16:31]
    buffer_load_dwordx4 v[180:183], v3, s[12:15], s31 offen offset:672
    v_exp_f32 v122, v122
    v_exp_f32 v123, v123
    v_exp_f32 v124, v124
    v_exp_f32 v125, v125
    s_waitcnt vmcnt(24)
    v_mfma_f32_32x32x16_bf16 a[0:15], a[132:135], a[128:131], a[0:15]
    s_add_u32 s31, s31, 2624
    v_exp_f32 v126, v126
    v_exp_f32 v127, v127
    v_cvt_pk_bf16_f32 v148, v120, v121
    v_cvt_pk_bf16_f32 v149, v122, v123
    v_cvt_pk_bf16_f32 v150, v124, v125
    v_cvt_pk_bf16_f32 v151, v126, v127
    v_mfma_f32_32x32x16_bf16 v[112:127], v[184:187], v[96:99], 0
    v_exp_f32 v128, v128
    v_exp_f32 v129, v129
    v_exp_f32 v130, v130
    v_exp_f32 v131, v131
    v_mfma_f32_32x32x16_bf16 v[16:31], v[196:199], v[148:151], v[16:31]
    buffer_load_dwordx4 a[104:107], v1, s[52:55], s56 offen offset:1024
    v_exp_f32 v132, v132
    v_exp_f32 v133, v133
    v_exp_f32 v134, v134
    v_exp_f32 v135, v135
    v_mfma_f32_32x32x16_bf16 v[112:127], v[188:191], v[100:103], v[112:127]
    buffer_load_dwordx4 a[108:111], v10, s[64:67], s58 offen offset:1024
    v_cvt_pk_bf16_f32 v144, v128, v129
    v_cvt_pk_bf16_f32 v145, v130, v131
    v_cvt_pk_bf16_f32 v146, v132, v133
    v_cvt_pk_bf16_f32 v147, v134, v135
    v_exp_f32 v136, v136
    v_exp_f32 v137, v137
    v_mfma_f32_32x32x16_bf16 v[32:47], v[192:195], v[144:147], v[32:47]
    v_exp_f32 v138, v138
    v_exp_f32 v139, v139
    v_exp_f32 v140, v140
    v_exp_f32 v141, v141
    v_mfma_f32_32x32x16_bf16 a[16:31], a[136:139], a[128:131], a[16:31]
    v_exp_f32 v142, v142
    v_exp_f32 v143, v143
    v_cvt_pk_bf16_f32 v148, v136, v137
    v_cvt_pk_bf16_f32 v149, v138, v139
    v_cvt_pk_bf16_f32 v150, v140, v141
    v_cvt_pk_bf16_f32 v151, v142, v143
    v_mfma_f32_32x32x16_bf16 v[128:143], v[184:187], v[104:107], 0
    v_exp_f32 v112, v112
    v_exp_f32 v113, v113
    v_exp_f32 v114, v114
    v_exp_f32 v115, v115
    v_mfma_f32_32x32x16_bf16 v[32:47], v[196:199], v[148:151], v[32:47]
    buffer_load_dwordx4 a[112:115], v11, s[64:67], s58 offen offset:1024
    v_exp_f32 v116, v116
    v_exp_f32 v117, v117
    v_exp_f32 v118, v118
    v_exp_f32 v119, v119
    v_mfma_f32_32x32x16_bf16 v[128:143], v[188:191], v[108:111], v[128:143]
    buffer_load_dwordx4 a[116:119], v12, s[64:67], s58 offen offset:1024
    v_cvt_pk_bf16_f32 v144, v112, v113
    v_cvt_pk_bf16_f32 v145, v114, v115
    v_cvt_pk_bf16_f32 v146, v116, v117
    v_cvt_pk_bf16_f32 v147, v118, v119
    v_exp_f32 v120, v120
    v_exp_f32 v121, v121
    v_mfma_f32_32x32x16_bf16 v[48:63], v[192:195], v[144:147], v[48:63]
    v_exp_f32 v122, v122
    v_exp_f32 v123, v123
    v_exp_f32 v124, v124
    v_exp_f32 v125, v125
    v_mfma_f32_32x32x16_bf16 a[32:47], a[140:143], a[128:131], a[32:47]
    v_exp_f32 v126, v126
    v_exp_f32 v127, v127
    v_cvt_pk_bf16_f32 v148, v120, v121
    v_cvt_pk_bf16_f32 v149, v122, v123
    v_cvt_pk_bf16_f32 v150, v124, v125
    v_cvt_pk_bf16_f32 v151, v126, v127
    s_waitcnt vmcnt(24)
    v_mfma_f32_32x32x16_bf16 v[112:127], v[200:203], v[80:83], 0
    v_exp_f32 v128, v128
    v_exp_f32 v129, v129
    v_exp_f32 v130, v130
    v_mfma_f32_32x32x16_bf16 v[48:63], v[196:199], v[148:151], v[48:63]
    buffer_load_dwordx4 a[120:123], v13, s[64:67], s58 offen offset:1024
    v_exp_f32 v131, v131
    v_exp_f32 v132, v132
    v_exp_f32 v133, v133
    v_mfma_f32_32x32x16_bf16 a[48:63], a[144:147], a[128:131], a[48:63]
    buffer_load_dwordx4 a[124:127], v14, s[64:67], s58 offen offset:1024
    v_exp_f32 v134, v134
    v_exp_f32 v135, v135
    v_cvt_pk_bf16_f32 v144, v128, v129
    v_cvt_pk_bf16_f32 v145, v130, v131
    v_mfma_f32_32x32x16_bf16 v[112:127], v[204:207], v[84:87], v[112:127]
    v_cvt_pk_bf16_f32 v146, v132, v133
    v_cvt_pk_bf16_f32 v147, v134, v135
    v_exp_f32 v136, v136
    v_exp_f32 v137, v137
    v_mfma_f32_32x32x16_bf16 v[64:79], v[192:195], v[144:147], v[64:79]
    v_exp_f32 v138, v138
    v_exp_f32 v139, v139
    v_exp_f32 v140, v140
    v_mfma_f32_32x32x16_bf16 a[64:79], a[148:151], a[128:131], a[64:79]
    v_exp_f32 v141, v141
    v_exp_f32 v142, v142
    v_exp_f32 v143, v143
    v_cvt_pk_bf16_f32 v148, v136, v137
    v_cvt_pk_bf16_f32 v149, v138, v139
    v_cvt_pk_bf16_f32 v150, v140, v141
    v_cvt_pk_bf16_f32 v151, v142, v143
    v_mfma_f32_32x32x16_bf16 v[128:143], v[200:203], v[88:91], 0
    buffer_load_dwordx4 v[184:187], v1, s[12:15], s31 offen
    v_exp_f32 v112, v112
    v_exp_f32 v113, v113
    v_exp_f32 v114, v114
    v_exp_f32 v115, v115
    v_mfma_f32_32x32x16_bf16 v[64:79], v[196:199], v[148:151], v[64:79]
    buffer_load_dwordx2 v[188:189], v2, s[12:15], s31 offen
    v_exp_f32 v116, v116
    v_exp_f32 v117, v117
    v_exp_f32 v118, v118
    v_exp_f32 v119, v119
    v_mfma_f32_32x32x16_bf16 v[128:143], v[204:207], v[92:95], v[128:143]
    buffer_load_dwordx4 v[192:195], v3, s[12:15], s31 offen
    v_cvt_pk_bf16_f32 v144, v112, v113
    v_cvt_pk_bf16_f32 v145, v114, v115
    v_cvt_pk_bf16_f32 v146, v116, v117
    v_cvt_pk_bf16_f32 v147, v118, v119
    v_exp_f32 v120, v120
    v_exp_f32 v121, v121
    v_mfma_f32_32x32x16_bf16 v[16:31], v[208:211], v[144:147], v[16:31]
    buffer_load_dwordx4 v[196:199], v3, s[12:15], s31 offen offset:672
    v_exp_f32 v122, v122
    v_exp_f32 v123, v123
    v_exp_f32 v124, v124
    v_exp_f32 v125, v125
    s_waitcnt vmcnt(24)
    v_mfma_f32_32x32x16_bf16 a[0:15], a[156:159], a[152:155], a[0:15]
    s_add_u32 s31, s31, 2624
    v_exp_f32 v126, v126
    v_exp_f32 v127, v127
    v_cvt_pk_bf16_f32 v148, v120, v121
    v_cvt_pk_bf16_f32 v149, v122, v123
    v_cvt_pk_bf16_f32 v150, v124, v125
    v_cvt_pk_bf16_f32 v151, v126, v127
    v_mfma_f32_32x32x16_bf16 v[112:127], v[200:203], v[96:99], 0
    v_exp_f32 v128, v128
    v_exp_f32 v129, v129
    v_exp_f32 v130, v130
    v_exp_f32 v131, v131
    v_mfma_f32_32x32x16_bf16 v[16:31], v[212:215], v[148:151], v[16:31]
    buffer_load_dwordx4 a[128:131], v1, s[52:55], s56 offen offset:2048
    v_exp_f32 v132, v132
    v_exp_f32 v133, v133
    v_exp_f32 v134, v134
    v_exp_f32 v135, v135
    v_mfma_f32_32x32x16_bf16 v[112:127], v[204:207], v[100:103], v[112:127]
    buffer_load_dwordx4 a[132:135], v10, s[64:67], s58 offen offset:2048
    v_cvt_pk_bf16_f32 v144, v128, v129
    v_cvt_pk_bf16_f32 v145, v130, v131
    v_cvt_pk_bf16_f32 v146, v132, v133
    v_cvt_pk_bf16_f32 v147, v134, v135
    v_exp_f32 v136, v136
    v_exp_f32 v137, v137
    v_mfma_f32_32x32x16_bf16 v[32:47], v[208:211], v[144:147], v[32:47]
    v_exp_f32 v138, v138
    v_exp_f32 v139, v139
    v_exp_f32 v140, v140
    v_exp_f32 v141, v141
    v_mfma_f32_32x32x16_bf16 a[16:31], a[160:163], a[152:155], a[16:31]
    v_exp_f32 v142, v142
    v_exp_f32 v143, v143
    v_cvt_pk_bf16_f32 v148, v136, v137
    v_cvt_pk_bf16_f32 v149, v138, v139
    v_cvt_pk_bf16_f32 v150, v140, v141
    v_cvt_pk_bf16_f32 v151, v142, v143
    v_mfma_f32_32x32x16_bf16 v[128:143], v[200:203], v[104:107], 0
    v_exp_f32 v112, v112
    v_exp_f32 v113, v113
    v_exp_f32 v114, v114
    v_exp_f32 v115, v115
    v_mfma_f32_32x32x16_bf16 v[32:47], v[212:215], v[148:151], v[32:47]
    buffer_load_dwordx4 a[136:139], v11, s[64:67], s58 offen offset:2048
    v_exp_f32 v116, v116
    v_exp_f32 v117, v117
    v_exp_f32 v118, v118
    v_exp_f32 v119, v119
    v_mfma_f32_32x32x16_bf16 v[128:143], v[204:207], v[108:111], v[128:143]
    buffer_load_dwordx4 a[140:143], v12, s[64:67], s58 offen offset:2048
    v_cvt_pk_bf16_f32 v144, v112, v113
    v_cvt_pk_bf16_f32 v145, v114, v115
    v_cvt_pk_bf16_f32 v146, v116, v117
    v_cvt_pk_bf16_f32 v147, v118, v119
    v_exp_f32 v120, v120
    v_exp_f32 v121, v121
    v_mfma_f32_32x32x16_bf16 v[48:63], v[208:211], v[144:147], v[48:63]
    v_exp_f32 v122, v122
    v_exp_f32 v123, v123
    v_exp_f32 v124, v124
    v_exp_f32 v125, v125
    v_mfma_f32_32x32x16_bf16 a[32:47], a[164:167], a[152:155], a[32:47]
    v_exp_f32 v126, v126
    v_exp_f32 v127, v127
    v_cvt_pk_bf16_f32 v148, v120, v121
    v_cvt_pk_bf16_f32 v149, v122, v123
    v_cvt_pk_bf16_f32 v150, v124, v125
    v_cvt_pk_bf16_f32 v151, v126, v127
    s_waitcnt vmcnt(24)
    v_mfma_f32_32x32x16_bf16 v[112:127], v[152:155], v[80:83], 0
    v_exp_f32 v128, v128
    v_exp_f32 v129, v129
    v_exp_f32 v130, v130
    v_mfma_f32_32x32x16_bf16 v[48:63], v[212:215], v[148:151], v[48:63]
    buffer_load_dwordx4 a[144:147], v13, s[64:67], s58 offen offset:2048
    v_exp_f32 v131, v131
    v_exp_f32 v132, v132
    v_exp_f32 v133, v133
    v_mfma_f32_32x32x16_bf16 a[48:63], a[168:171], a[152:155], a[48:63]
    buffer_load_dwordx4 a[148:151], v14, s[64:67], s58 offen offset:2048
    v_exp_f32 v134, v134
    v_exp_f32 v135, v135
    v_cvt_pk_bf16_f32 v144, v128, v129
    v_cvt_pk_bf16_f32 v145, v130, v131
    v_mfma_f32_32x32x16_bf16 v[112:127], v[156:159], v[84:87], v[112:127]
    v_cvt_pk_bf16_f32 v146, v132, v133
    v_cvt_pk_bf16_f32 v147, v134, v135
    v_exp_f32 v136, v136
    v_exp_f32 v137, v137
    v_mfma_f32_32x32x16_bf16 v[64:79], v[208:211], v[144:147], v[64:79]
    v_exp_f32 v138, v138
    v_exp_f32 v139, v139
    v_exp_f32 v140, v140
    v_mfma_f32_32x32x16_bf16 a[64:79], a[172:175], a[152:155], a[64:79]
    v_exp_f32 v141, v141
    v_exp_f32 v142, v142
    v_exp_f32 v143, v143
    v_cvt_pk_bf16_f32 v148, v136, v137
    v_cvt_pk_bf16_f32 v149, v138, v139
    v_cvt_pk_bf16_f32 v150, v140, v141
    v_cvt_pk_bf16_f32 v151, v142, v143
    s_add_u32 s33, s33, 1
    s_cmp_lt_u32 s33, 7
    s_cbranch_scc1 K2_LOOP
    s_add_u32 s48, s4, 0x1300000
    s_addc_u32 s49, s5, 0
    s_mov_b32 s50, 0xc8000
    s_mov_b32 s51, 0x00020000
    v_add_u32 v10, 0x0, v1
    v_add_u32 v11, 0xa000, v1
    v_add_u32 v12, 0x14000, v1
    v_add_u32 v13, 0x1e000, v1
    v_add_u32 v14, 0x28000, v1
    s_mul_i32 s27, s24, 10
    s_mul_i32 s28, s39, 200
    s_add_u32 s28, s28, s27
    s_lshl_b32 s41, s28, 10
    s_add_u32 s42, s41, 4096
    s_add_u32 s43, s41, 8192
    s_mul_i32 s28, s38, 40
    s_add_u32 s28, s28, s27
    s_lshl_b32 s56, s28, 10
    v_mfma_f32_32x32x16_bf16 v[128:143], v[152:155], v[88:91], 0
    buffer_load_dwordx4 v[200:203], v1, s[12:15], s31 offen
    v_exp_f32 v112, v112
    v_exp_f32 v113, v113
    v_exp_f32 v114, v114
    v_exp_f32 v115, v115
    v_mfma_f32_32x32x16_bf16 v[64:79], v[212:215], v[148:151], v[64:79]
    buffer_load_dwordx2 v[204:205], v2, s[12:15], s31 offen
    v_exp_f32 v116, v116
    v_exp_f32 v117, v117
    v_exp_f32 v118, v118
    v_exp_f32 v119, v119
    v_mfma_f32_32x32x16_bf16 v[128:143], v[156:159], v[92:95], v[128:143]
    buffer_load_dwordx4 v[208:211], v3, s[12:15], s31 offen
    v_cvt_pk_bf16_f32 v144, v112, v113
    v_cvt_pk_bf16_f32 v145, v114, v115
    v_cvt_pk_bf16_f32 v146, v116, v117
    v_cvt_pk_bf16_f32 v147, v118, v119
    v_exp_f32 v120, v120
    v_exp_f32 v121, v121
    v_exp_f32 v122, v122
    v_exp_f32 v123, v123
    v_mfma_f32_32x32x16_bf16 v[16:31], v[160:163], v[144:147], v[16:31]
    buffer_load_dwordx4 v[212:215], v3, s[12:15], s31 offen offset:672
    s_add_u32 s31, s31, 2624
    v_exp_f32 v124, v124
    v_exp_f32 v125, v125
    v_exp_f32 v126, v126
    v_exp_f32 v127, v127
    v_cvt_pk_bf16_f32 v148, v120, v121
    v_cvt_pk_bf16_f32 v149, v122, v123
    v_cvt_pk_bf16_f32 v150, v124, v125
    v_cvt_pk_bf16_f32 v151, v126, v127
    buffer_load_dwordx4 a[80:83], v10, s[48:51], s41 offen offset:0
    buffer_load_dwordx4 a[84:87], v11, s[48:51], s41 offen offset:0
    buffer_load_dwordx4 a[88:91], v12, s[48:51], s41 offen offset:0
    v_mfma_f32_32x32x16_bf16 v[112:127], v[152:155], v[96:99], 0
    buffer_load_dwordx4 a[92:95], v13, s[48:51], s41 offen offset:0
    v_exp_f32 v128, v128
    v_exp_f32 v129, v129
    v_exp_f32 v130, v130
    v_exp_f32 v131, v131
    v_mfma_f32_32x32x16_bf16 v[16:31], v[164:167], v[148:151], v[16:31]
    buffer_load_dwordx4 a[96:99], v14, s[48:51], s41 offen offset:0
    v_exp_f32 v132, v132
    v_exp_f32 v133, v133
    v_exp_f32 v134, v134
    v_exp_f32 v135, v135
    v_mfma_f32_32x32x16_bf16 v[112:127], v[156:159], v[100:103], v[112:127]
    buffer_load_dwordx4 a[100:103], v10, s[48:51], s41 offen offset:1024
    v_cvt_pk_bf16_f32 v144, v128, v129
    v_cvt_pk_bf16_f32 v145, v130, v131
    v_cvt_pk_bf16_f32 v146, v132, v133
    v_cvt_pk_bf16_f32 v147, v134, v135
    v_exp_f32 v136, v136
    v_exp_f32 v137, v137
    v_exp_f32 v138, v138
    v_exp_f32 v139, v139
    v_mfma_f32_32x32x16_bf16 v[32:47], v[160:163], v[144:147], v[32:47]
    v_exp_f32 v140, v140
    v_exp_f32 v141, v141
    v_exp_f32 v142, v142
    v_exp_f32 v143, v143
    v_cvt_pk_bf16_f32 v148, v136, v137
    v_cvt_pk_bf16_f32 v149, v138, v139
    v_cvt_pk_bf16_f32 v150, v140, v141
    v_cvt_pk_bf16_f32 v151, v142, v143
    v_mfma_f32_32x32x16_bf16 v[128:143], v[152:155], v[104:107], 0
    buffer_load_dwordx4 a[104:107], v11, s[48:51], s41 offen offset:1024
    v_exp_f32 v112, v112
    v_exp_f32 v113, v113
    v_exp_f32 v114, v114
    v_exp_f32 v115, v115
    v_mfma_f32_32x32x16_bf16 v[32:47], v[164:167], v[148:151], v[32:47]
    buffer_load_dwordx4 a[108:111], v12, s[48:51], s41 offen offset:1024
    v_exp_f32 v116, v116
    v_exp_f32 v117, v117
    v_exp_f32 v118, v118
    v_exp_f32 v119, v119
    v_mfma_f32_32x32x16_bf16 v[128:143], v[156:159], v[108:111], v[128:143]
    buffer_load_dwordx4 a[112:115], v13, s[48:51], s41 offen offset:1024
    v_cvt_pk_bf16_f32 v144, v112, v113
    v_cvt_pk_bf16_f32 v145, v114, v115
    v_cvt_pk_bf16_f32 v146, v116, v117
    v_cvt_pk_bf16_f32 v147, v118, v119
    v_exp_f32 v120, v120
    v_exp_f32 v121, v121
    v_exp_f32 v122, v122
    v_exp_f32 v123, v123
    v_mfma_f32_32x32x16_bf16 v[48:63], v[160:163], v[144:147], v[48:63]
    v_exp_f32 v124, v124
    v_exp_f32 v125, v125
    v_exp_f32 v126, v126
    v_exp_f32 v127, v127
    v_cvt_pk_bf16_f32 v148, v120, v121
    v_cvt_pk_bf16_f32 v149, v122, v123
    v_cvt_pk_bf16_f32 v150, v124, v125
    v_cvt_pk_bf16_f32 v151, v126, v127
    s_waitcnt vmcnt(20)
    v_mfma_f32_32x32x16_bf16 v[112:127], v[168:171], v[80:83], 0
    buffer_load_dwordx4 a[116:119], v14, s[48:51], s41 offen offset:1024
    v_exp_f32 v128, v128
    v_exp_f32 v129, v129
    v_exp_f32 v130, v130
    v_exp_f32 v131, v131
    v_mfma_f32_32x32x16_bf16 v[48:63], v[164:167], v[148:151], v[48:63]
    buffer_load_dwordx4 a[120:123], v10, s[48:51], s41 offen offset:2048
    v_exp_f32 v132, v132
    v_exp_f32 v133, v133
    v_exp_f32 v134, v134
    v_exp_f32 v135, v135
    v_mfma_f32_32x32x16_bf16 v[112:127], v[172:175], v[84:87], v[112:127]
    buffer_load_dwordx4 a[124:127], v11, s[48:51], s41 offen offset:2048
    v_cvt_pk_bf16_f32 v144, v128, v129
    v_cvt_pk_bf16_f32 v145, v130, v131
    v_cvt_pk_bf16_f32 v146, v132, v133
    v_cvt_pk_bf16_f32 v147, v134, v135
    v_exp_f32 v136, v136
    v_exp_f32 v137, v137
    v_exp_f32 v138, v138
    v_exp_f32 v139, v139
    v_mfma_f32_32x32x16_bf16 v[64:79], v[160:163], v[144:147], v[64:79]
    v_exp_f32 v140, v140
    v_exp_f32 v141, v141
    v_exp_f32 v142, v142
    v_exp_f32 v143, v143
    v_cvt_pk_bf16_f32 v148, v136, v137
    v_cvt_pk_bf16_f32 v149, v138, v139
    v_cvt_pk_bf16_f32 v150, v140, v141
    v_cvt_pk_bf16_f32 v151, v142, v143
    v_mfma_f32_32x32x16_bf16 v[128:143], v[168:171], v[88:91], 0
    buffer_load_dwordx4 a[128:131], v12, s[48:51], s41 offen offset:2048
    v_exp_f32 v112, v112
    v_exp_f32 v113, v113
    v_exp_f32 v114, v114
    v_exp_f32 v115, v115
    v_mfma_f32_32x32x16_bf16 v[64:79], v[164:167], v[148:151], v[64:79]
    buffer_load_dwordx4 a[132:135], v13, s[48:51], s41 offen offset:2048
    v_exp_f32 v116, v116
    v_exp_f32 v117, v117
    v_exp_f32 v118, v118
    v_exp_f32 v119, v119
    v_mfma_f32_32x32x16_bf16 v[128:143], v[172:175], v[92:95], v[128:143]
    buffer_load_dwordx4 a[136:139], v14, s[48:51], s41 offen offset:2048
    v_cvt_pk_bf16_f32 v144, v112, v113
    v_cvt_pk_bf16_f32 v145, v114, v115
    v_cvt_pk_bf16_f32 v146, v116, v117
    v_cvt_pk_bf16_f32 v147, v118, v119
    v_exp_f32 v120, v120
    v_exp_f32 v121, v121
    v_exp_f32 v122, v122
    v_exp_f32 v123, v123
    v_mfma_f32_32x32x16_bf16 v[16:31], v[176:179], v[144:147], v[16:31]
    v_exp_f32 v124, v124
    v_exp_f32 v125, v125
    v_exp_f32 v126, v126
    v_exp_f32 v127, v127
    v_cvt_pk_bf16_f32 v148, v120, v121
    v_cvt_pk_bf16_f32 v149, v122, v123
    v_cvt_pk_bf16_f32 v150, v124, v125
    v_cvt_pk_bf16_f32 v151, v126, v127
    v_mfma_f32_32x32x16_bf16 v[112:127], v[168:171], v[96:99], 0
    buffer_load_dwordx4 a[140:143], v10, s[48:51], s41 offen offset:3072
    v_exp_f32 v128, v128
    v_exp_f32 v129, v129
    v_exp_f32 v130, v130
    v_exp_f32 v131, v131
    v_mfma_f32_32x32x16_bf16 v[16:31], v[180:183], v[148:151], v[16:31]
    buffer_load_dwordx4 a[144:147], v11, s[48:51], s41 offen offset:3072
    v_exp_f32 v132, v132
    v_exp_f32 v133, v133
    v_exp_f32 v134, v134
    v_exp_f32 v135, v135
    v_mfma_f32_32x32x16_bf16 v[112:127], v[172:175], v[100:103], v[112:127]
    buffer_load_dwordx4 a[148:151], v12, s[48:51], s41 offen offset:3072
    v_cvt_pk_bf16_f32 v144, v128, v129
    v_cvt_pk_bf16_f32 v145, v130, v131
    v_cvt_pk_bf16_f32 v146, v132, v133
    v_cvt_pk_bf16_f32 v147, v134, v135
    v_exp_f32 v136, v136
    v_exp_f32 v137, v137
    v_exp_f32 v138, v138
    v_exp_f32 v139, v139
    v_mfma_f32_32x32x16_bf16 v[32:47], v[176:179], v[144:147], v[32:47]
    v_exp_f32 v140, v140
    v_exp_f32 v141, v141
    v_exp_f32 v142, v142
    v_exp_f32 v143, v143
    v_cvt_pk_bf16_f32 v148, v136, v137
    v_cvt_pk_bf16_f32 v149, v138, v139
    v_cvt_pk_bf16_f32 v150, v140, v141
    v_cvt_pk_bf16_f32 v151, v142, v143
    v_mfma_f32_32x32x16_bf16 v[128:143], v[168:171], v[104:107], 0
    buffer_load_dwordx4 a[152:155], v13, s[48:51], s41 offen offset:3072
    v_exp_f32 v112, v112
    v_exp_f32 v113, v113
    v_exp_f32 v114, v114
    v_exp_f32 v115, v115
    v_mfma_f32_32x32x16_bf16 v[32:47], v[180:183], v[148:151], v[32:47]
    buffer_load_dwordx4 a[156:159], v14, s[48:51], s41 offen offset:3072
    v_exp_f32 v116, v116
    v_exp_f32 v117, v117
    v_exp_f32 v118, v118
    v_exp_f32 v119, v119
    v_mfma_f32_32x32x16_bf16 v[128:143], v[172:175], v[108:111], v[128:143]
    buffer_load_dwordx4 a[160:163], v10, s[48:51], s42 offen offset:0
    v_cvt_pk_bf16_f32 v144, v112, v113
    v_cvt_pk_bf16_f32 v145, v114, v115
    v_cvt_pk_bf16_f32 v146, v116, v117
    v_cvt_pk_bf16_f32 v147, v118, v119
    v_exp_f32 v120, v120
    v_exp_f32 v121, v121
    v_exp_f32 v122, v122
    v_exp_f32 v123, v123
    v_mfma_f32_32x32x16_bf16 v[48:63], v[176:179], v[144:147], v[48:63]
    v_exp_f32 v124, v124
    v_exp_f32 v125, v125
    v_exp_f32 v126, v126
    v_exp_f32 v127, v127
    v_cvt_pk_bf16_f32 v148, v120, v121
    v_cvt_pk_bf16_f32 v149, v122, v123
    v_cvt_pk_bf16_f32 v150, v124, v125
    v_cvt_pk_bf16_f32 v151, v126, v127
    s_waitcnt vmcnt(10)
    v_mfma_f32_32x32x16_bf16 v[112:127], v[184:187], v[80:83], 0
    buffer_load_dwordx4 a[164:167], v11, s[48:51], s42 offen offset:0
    v_exp_f32 v128, v128
    v_exp_f32 v129, v129
    v_exp_f32 v130, v130
    v_exp_f32 v131, v131
    v_mfma_f32_32x32x16_bf16 v[48:63], v[180:183], v[148:151], v[48:63]
    buffer_load_dwordx4 a[168:171], v12, s[48:51], s42 offen offset:0
    v_exp_f32 v132, v132
    v_exp_f32 v133, v133
    v_exp_f32 v134, v134
    v_exp_f32 v135, v135
    v_mfma_f32_32x32x16_bf16 v[112:127], v[188:191], v[84:87], v[112:127]
    buffer_load_dwordx4 a[172:175], v13, s[48:51], s42 offen offset:0
    v_cvt_pk_bf16_f32 v144, v128, v129
    v_cvt_pk_bf16_f32 v145, v130, v131
    v_cvt_pk_bf16_f32 v146, v132, v133
    v_cvt_pk_bf16_f32 v147, v134, v135
    v_exp_f32 v136, v136
    v_exp_f32 v137, v137
    v_exp_f32 v138, v138
    v_exp_f32 v139, v139
    v_mfma_f32_32x32x16_bf16 v[64:79], v[176:179], v[144:147], v[64:79]
    v_exp_f32 v140, v140
    v_exp_f32 v141, v141
    v_exp_f32 v142, v142
    v_exp_f32 v143, v143
    v_cvt_pk_bf16_f32 v148, v136, v137
    v_cvt_pk_bf16_f32 v149, v138, v139
    v_cvt_pk_bf16_f32 v150, v140, v141
    v_cvt_pk_bf16_f32 v151, v142, v143
    v_mfma_f32_32x32x16_bf16 v[128:143], v[184:187], v[88:91], 0
    buffer_load_dwordx4 a[176:179], v14, s[48:51], s42 offen offset:0
    v_exp_f32 v112, v112
    v_exp_f32 v113, v113
    v_exp_f32 v114, v114
    v_exp_f32 v115, v115
    v_mfma_f32_32x32x16_bf16 v[64:79], v[180:183], v[148:151], v[64:79]
    buffer_load_dwordx4 a[180:183], v10, s[48:51], s42 offen offset:1024
    v_exp_f32 v116, v116
    v_exp_f32 v117, v117
    v_exp_f32 v118, v118
    v_exp_f32 v119, v119
    v_mfma_f32_32x32x16_bf16 v[128:143], v[188:191], v[92:95], v[128:143]
    buffer_load_dwordx4 a[184:187], v11, s[48:51], s42 offen offset:1024
    v_cvt_pk_bf16_f32 v144, v112, v113
    v_cvt_pk_bf16_f32 v145, v114, v115
    v_cvt_pk_bf16_f32 v146, v116, v117
    v_cvt_pk_bf16_f32 v147, v118, v119
    v_exp_f32 v120, v120
    v_exp_f32 v121, v121
    v_exp_f32 v122, v122
    v_exp_f32 v123, v123
    v_mfma_f32_32x32x16_bf16 v[16:31], v[192:195], v[144:147], v[16:31]
    v_exp_f32 v124, v124
    v_exp_f32 v125, v125
    v_exp_f32 v126, v126
    v_exp_f32 v127, v127
    v_cvt_pk_bf16_f32 v148, v120, v121
    v_cvt_pk_bf16_f32 v149, v122, v123
    v_cvt_pk_bf16_f32 v150, v124, v125
    v_cvt_pk_bf16_f32 v151, v126, v127
    v_mfma_f32_32x32x16_bf16 v[112:127], v[184:187], v[96:99], 0
    buffer_load_dwordx4 a[188:191], v12, s[48:51], s42 offen offset:1024
    v_exp_f32 v128, v128
    v_exp_f32 v129, v129
    v_exp_f32 v130, v130
    v_exp_f32 v131, v131
    v_mfma_f32_32x32x16_bf16 v[16:31], v[196:199], v[148:151], v[16:31]
    buffer_load_dwordx4 a[192:195], v13, s[48:51], s42 offen offset:1024
    v_exp_f32 v132, v132
    v_exp_f32 v133, v133
    v_exp_f32 v134, v134
    v_exp_f32 v135, v135
    v_mfma_f32_32x32x16_bf16 v[112:127], v[188:191], v[100:103], v[112:127]
    buffer_load_dwordx4 a[196:199], v14, s[48:51], s42 offen offset:1024
    v_cvt_pk_bf16_f32 v144, v128, v129
    v_cvt_pk_bf16_f32 v145, v130, v131
    v_cvt_pk_bf16_f32 v146, v132, v133
    v_cvt_pk_bf16_f32 v147, v134, v135
    v_exp_f32 v136, v136
    v_exp_f32 v137, v137
    v_exp_f32 v138, v138
    v_exp_f32 v139, v139
    v_mfma_f32_32x32x16_bf16 v[32:47], v[192:195], v[144:147], v[32:47]
    v_exp_f32 v140, v140
    v_exp_f32 v141, v141
    v_exp_f32 v142, v142
    v_exp_f32 v143, v143
    v_cvt_pk_bf16_f32 v148, v136, v137
    v_cvt_pk_bf16_f32 v149, v138, v139
    v_cvt_pk_bf16_f32 v150, v140, v141
    v_cvt_pk_bf16_f32 v151, v142, v143
    v_mfma_f32_32x32x16_bf16 v[128:143], v[184:187], v[104:107], 0
    buffer_load_dwordx4 a[200:203], v10, s[48:51], s42 offen offset:2048
    v_exp_f32 v112, v112
    v_exp_f32 v113, v113
    v_exp_f32 v114, v114
    v_exp_f32 v115, v115
    v_mfma_f32_32x32x16_bf16 v[32:47], v[196:199], v[148:151], v[32:47]
    buffer_load_dwordx4 a[204:207], v11, s[48:51], s42 offen offset:2048
    v_exp_f32 v116, v116
    v_exp_f32 v117, v117
    v_exp_f32 v118, v118
    v_exp_f32 v119, v119
    v_mfma_f32_32x32x16_bf16 v[128:143], v[188:191], v[108:111], v[128:143]
    buffer_load_dwordx4 a[208:211], v12, s[48:51], s42 offen offset:2048
    v_cvt_pk_bf16_f32 v144, v112, v113
    v_cvt_pk_bf16_f32 v145, v114, v115
    v_cvt_pk_bf16_f32 v146, v116, v117
    v_cvt_pk_bf16_f32 v147, v118, v119
    v_exp_f32 v120, v120
    v_exp_f32 v121, v121
    v_exp_f32 v122, v122
    v_exp_f32 v123, v123
    v_mfma_f32_32x32x16_bf16 v[48:63], v[192:195], v[144:147], v[48:63]
    v_exp_f32 v124, v124
    v_exp_f32 v125, v125
    v_exp_f32 v126, v126
    v_exp_f32 v127, v127
    v_cvt_pk_bf16_f32 v148, v120, v121
    v_cvt_pk_bf16_f32 v149, v122, v123
    v_cvt_pk_bf16_f32 v150, v124, v125
    v_cvt_pk_bf16_f32 v151, v126, v127
    s_waitcnt vmcnt(0)
    v_mfma_f32_32x32x16_bf16 v[112:127], v[200:203], v[80:83], 0
    buffer_load_dwordx4 a[212:215], v13, s[48:51], s42 offen offset:2048
    v_exp_f32 v128, v128
    v_exp_f32 v129, v129
    v_exp_f32 v130, v130
    v_exp_f32 v131, v131
    v_mfma_f32_32x32x16_bf16 v[48:63], v[196:199], v[148:151], v[48:63]
    buffer_load_dwordx4 a[216:219], v14, s[48:51], s42 offen offset:2048
    v_exp_f32 v132, v132
    v_exp_f32 v133, v133
    v_exp_f32 v134, v134
    v_exp_f32 v135, v135
    v_mfma_f32_32x32x16_bf16 v[112:127], v[204:207], v[84:87], v[112:127]
    buffer_load_dwordx4 a[220:223], v10, s[48:51], s42 offen offset:3072
    v_cvt_pk_bf16_f32 v144, v128, v129
    v_cvt_pk_bf16_f32 v145, v130, v131
    v_cvt_pk_bf16_f32 v146, v132, v133
    v_cvt_pk_bf16_f32 v147, v134, v135
    v_exp_f32 v136, v136
    v_exp_f32 v137, v137
    v_exp_f32 v138, v138
    v_exp_f32 v139, v139
    v_mfma_f32_32x32x16_bf16 v[64:79], v[192:195], v[144:147], v[64:79]
    v_exp_f32 v140, v140
    v_exp_f32 v141, v141
    v_exp_f32 v142, v142
    v_exp_f32 v143, v143
    v_cvt_pk_bf16_f32 v148, v136, v137
    v_cvt_pk_bf16_f32 v149, v138, v139
    v_cvt_pk_bf16_f32 v150, v140, v141
    v_cvt_pk_bf16_f32 v151, v142, v143
    v_mfma_f32_32x32x16_bf16 v[128:143], v[200:203], v[88:91], 0
    buffer_load_dwordx4 a[224:227], v11, s[48:51], s42 offen offset:3072
    v_exp_f32 v112, v112
    v_exp_f32 v113, v113
    v_exp_f32 v114, v114
    v_exp_f32 v115, v115
    v_mfma_f32_32x32x16_bf16 v[64:79], v[196:199], v[148:151], v[64:79]
    buffer_load_dwordx4 a[228:231], v12, s[48:51], s42 offen offset:3072
    v_exp_f32 v116, v116
    v_exp_f32 v117, v117
    v_exp_f32 v118, v118
    v_exp_f32 v119, v119
    v_mfma_f32_32x32x16_bf16 v[128:143], v[204:207], v[92:95], v[128:143]
    buffer_load_dwordx4 a[232:235], v13, s[48:51], s42 offen offset:3072
    v_cvt_pk_bf16_f32 v144, v112, v113
    v_cvt_pk_bf16_f32 v145, v114, v115
    v_cvt_pk_bf16_f32 v146, v116, v117
    v_cvt_pk_bf16_f32 v147, v118, v119
    v_exp_f32 v120, v120
    v_exp_f32 v121, v121
    v_exp_f32 v122, v122
    v_exp_f32 v123, v123
    v_mfma_f32_32x32x16_bf16 v[16:31], v[208:211], v[144:147], v[16:31]
    v_exp_f32 v124, v124
    v_exp_f32 v125, v125
    v_exp_f32 v126, v126
    v_exp_f32 v127, v127
    v_cvt_pk_bf16_f32 v148, v120, v121
    v_cvt_pk_bf16_f32 v149, v122, v123
    v_cvt_pk_bf16_f32 v150, v124, v125
    v_cvt_pk_bf16_f32 v151, v126, v127
    v_mfma_f32_32x32x16_bf16 v[112:127], v[200:203], v[96:99], 0
    buffer_load_dwordx4 a[236:239], v14, s[48:51], s42 offen offset:3072
    v_exp_f32 v128, v128
    v_exp_f32 v129, v129
    v_exp_f32 v130, v130
    v_exp_f32 v131, v131
    v_mfma_f32_32x32x16_bf16 v[16:31], v[212:215], v[148:151], v[16:31]
    buffer_load_dwordx4 a[240:243], v10, s[48:51], s43 offen offset:0
    v_exp_f32 v132, v132
    v_exp_f32 v133, v133
    v_exp_f32 v134, v134
    v_exp_f32 v135, v135
    v_mfma_f32_32x32x16_bf16 v[112:127], v[204:207], v[100:103], v[112:127]
    buffer_load_dwordx4 a[244:247], v11, s[48:51], s43 offen offset:0
    v_cvt_pk_bf16_f32 v144, v128, v129
    v_cvt_pk_bf16_f32 v145, v130, v131
    v_cvt_pk_bf16_f32 v146, v132, v133
    v_cvt_pk_bf16_f32 v147, v134, v135
    v_exp_f32 v136, v136
    v_exp_f32 v137, v137
    v_exp_f32 v138, v138
    v_exp_f32 v139, v139
    v_mfma_f32_32x32x16_bf16 v[32:47], v[208:211], v[144:147], v[32:47]
    v_exp_f32 v140, v140
    v_exp_f32 v141, v141
    v_exp_f32 v142, v142
    v_exp_f32 v143, v143
    v_cvt_pk_bf16_f32 v148, v136, v137
    v_cvt_pk_bf16_f32 v149, v138, v139
    v_cvt_pk_bf16_f32 v150, v140, v141
    v_cvt_pk_bf16_f32 v151, v142, v143
    v_mfma_f32_32x32x16_bf16 v[128:143], v[200:203], v[104:107], 0
    buffer_load_dwordx4 a[248:251], v12, s[48:51], s43 offen offset:0
    v_exp_f32 v112, v112
    v_exp_f32 v113, v113
    v_exp_f32 v114, v114
    v_exp_f32 v115, v115
    v_mfma_f32_32x32x16_bf16 v[32:47], v[212:215], v[148:151], v[32:47]
    buffer_load_dwordx4 a[252:255], v13, s[48:51], s43 offen offset:0
    v_exp_f32 v116, v116
    v_exp_f32 v117, v117
    v_exp_f32 v118, v118
    v_exp_f32 v119, v119
    v_mfma_f32_32x32x16_bf16 v[128:143], v[204:207], v[108:111], v[128:143]
    buffer_load_dwordx4 v[152:155], v14, s[48:51], s43 offen offset:0
    v_cvt_pk_bf16_f32 v144, v112, v113
    v_cvt_pk_bf16_f32 v145, v114, v115
    v_cvt_pk_bf16_f32 v146, v116, v117
    v_cvt_pk_bf16_f32 v147, v118, v119
    v_exp_f32 v120, v120
    v_exp_f32 v121, v121
    v_exp_f32 v122, v122
    v_exp_f32 v123, v123
    v_mfma_f32_32x32x16_bf16 v[48:63], v[208:211], v[144:147], v[48:63]
    v_exp_f32 v124, v124
    v_exp_f32 v125, v125
    v_exp_f32 v126, v126
    v_exp_f32 v127, v127
    v_cvt_pk_bf16_f32 v148, v120, v121
    v_cvt_pk_bf16_f32 v149, v122, v123
    v_cvt_pk_bf16_f32 v150, v124, v125
    v_cvt_pk_bf16_f32 v151, v126, v127
    buffer_load_dwordx4 v[156:159], v10, s[48:51], s43 offen offset:1024
    v_exp_f32 v128, v128
    v_exp_f32 v129, v129
    v_exp_f32 v130, v130
    v_exp_f32 v131, v131
    v_mfma_f32_32x32x16_bf16 v[48:63], v[212:215], v[148:151], v[48:63]
    buffer_load_dwordx4 v[160:163], v11, s[48:51], s43 offen offset:1024
    v_exp_f32 v132, v132
    v_exp_f32 v133, v133
    v_exp_f32 v134, v134
    v_exp_f32 v135, v135
    buffer_load_dwordx4 v[164:167], v12, s[48:51], s43 offen offset:1024
    v_cvt_pk_bf16_f32 v144, v128, v129
    v_cvt_pk_bf16_f32 v145, v130, v131
    v_cvt_pk_bf16_f32 v146, v132, v133
    v_cvt_pk_bf16_f32 v147, v134, v135
    v_exp_f32 v136, v136
    v_exp_f32 v137, v137
    v_exp_f32 v138, v138
    v_exp_f32 v139, v139
    v_mfma_f32_32x32x16_bf16 v[64:79], v[208:211], v[144:147], v[64:79]
    v_exp_f32 v140, v140
    v_exp_f32 v141, v141
    v_exp_f32 v142, v142
    v_exp_f32 v143, v143
    v_cvt_pk_bf16_f32 v148, v136, v137
    v_cvt_pk_bf16_f32 v149, v138, v139
    v_cvt_pk_bf16_f32 v150, v140, v141
    v_cvt_pk_bf16_f32 v151, v142, v143
    s_nop 1
    v_mfma_f32_32x32x16_bf16 v[64:79], v[212:215], v[148:151], v[64:79]
    buffer_load_dwordx4 v[168:171], v13, s[48:51], s43 offen offset:1024
    buffer_load_dwordx4 v[172:175], v14, s[48:51], s43 offen offset:1024
    s_add_u32 s16, s4, 0x1400000
    s_addc_u32 s17, s5, 0
    s_mov_b32 s18, 0x280000
    s_mov_b32 s19, 0x00020000
    s_mov_b32 s8, s68
    s_mov_b32 s9, s69
    s_mov_b32 s10, 0x280000
    s_mov_b32 s11, 0x00020000
    s_mov_b32 s20, s62
    s_mov_b32 s21, s63
    s_mov_b32 s22, 0x280000
    s_mov_b32 s23, 0x00020000
    s_cmp_eq_u32 s37, 0
    s_cbranch_scc1 K2_X0
    ds_write_b128 v216, v[16:19] offset:0
    ds_write_b128 v216, v[20:23] offset:1024
    ds_write_b128 v216, v[24:27] offset:2048
    ds_write_b128 v216, v[32:35] offset:3072
    ds_write_b128 v216, v[36:39] offset:4096
    ds_write_b128 v216, v[40:43] offset:5120
    s_nop 3
    v_mov_b64 v[16:17], v[48:49]
    v_mov_b64 v[18:19], v[50:51]
    v_mov_b64 v[20:21], v[52:53]
    v_mov_b64 v[22:23], v[54:55]
    v_mov_b64 v[24:25], v[56:57]
    v_mov_b64 v[26:27], v[58:59]
    v_mov_b64 v[32:33], v[64:65]
    v_mov_b64 v[34:35], v[66:67]
    v_mov_b64 v[36:37], v[68:69]
    v_mov_b64 v[38:39], v[70:71]
    v_mov_b64 v[40:41], v[72:73]
    v_mov_b64 v[42:43], v[74:75]
    s_branch K2_X1
K2_X0:
    s_nop 1
    ds_write_b128 v216, v[48:51] offset:0
    ds_write_b128 v216, v[52:55] offset:1024
    ds_write_b128 v216, v[56:59] offset:2048
    ds_write_b128 v216, v[64:67] offset:3072
    ds_write_b128 v216, v[68:71] offset:4096
    ds_write_b128 v216, v[72:75] offset:5120
K2_X1:
    s_waitcnt lgkmcnt(0)
    s_barrier
    ds_read_b128 v[112:115], v217 offset:0
    ds_read_b128 v[116:119], v217 offset:1024
    ds_read_b128 v[120:123], v217 offset:2048
    ds_read_b128 v[124:127], v217 offset:3072
    ds_read_b128 v[128:131], v217 offset:4096
    ds_read_b128 v[132:135], v217 offset:5120
    s_waitcnt lgkmcnt(3)
    v_add_f32 v16, v16, v112
    v_add_f32 v17, v17, v113
    v_add_f32 v18, v18, v114
    v_add_f32 v19, v19, v115
    v_add_f32 v20, v20, v116
    v_add_f32 v21, v21, v117
    v_add_f32 v22, v22, v118
    v_add_f32 v23, v23, v119
    v_add_f32 v24, v24, v120
    v_add_f32 v25, v25, v121
    v_add_f32 v26, v26, v122
    v_add_f32 v27, v27, v123
    v_mov_b32 v9, v24
    v_mov_b32 v10, v24
    s_nop 1
    v_permlane32_swap_b32 v9, v10
    s_nop 1
    v_rcp_f32 v10, v10
    s_nop 0
    v_mul_f32 v16, v16, v10
    v_mul_f32 v17, v17, v10
    v_mul_f32 v18, v18, v10
    v_mul_f32 v19, v19, v10
    v_mul_f32 v20, v20, v10
    v_mul_f32 v21, v21, v10
    v_mul_f32 v22, v22, v10
    v_mul_f32 v23, v23, v10
    v_mul_f32 v24, v24, v10
    v_mul_f32 v25, v25, v10
    v_mul_f32 v26, v26, v10
    v_mul_f32 v27, v27, v10
    v_cvt_pk_bf16_f32 v144, v16, v17
    v_cvt_pk_bf16_f32 v145, v18, v19
    v_cvt_pk_bf16_f32 v146, v20, v21
    v_cvt_pk_bf16_f32 v147, v22, v23
    v_cvt_pk_bf16_f32 v148, v24, v25
    v_cvt_pk_bf16_f32 v149, v26, v27
    buffer_store_dwordx2 v[144:145], v224, s[16:19], s7 offen sc1
    buffer_store_dwordx2 v[146:147], v225, s[16:19], s7 offen sc1
    buffer_store_dwordx2 v[148:149], v226, s[16:19], s7 offen sc1
    s_add_u32 s7, s7, 40960
    s_waitcnt lgkmcnt(0)
    v_add_f32 v32, v32, v124
    v_add_f32 v33, v33, v125
    v_add_f32 v34, v34, v126
    v_add_f32 v35, v35, v127
    v_add_f32 v36, v36, v128
    v_add_f32 v37, v37, v129
    v_add_f32 v38, v38, v130
    v_add_f32 v39, v39, v131
    v_add_f32 v40, v40, v132
    v_add_f32 v41, v41, v133
    v_add_f32 v42, v42, v134
    v_add_f32 v43, v43, v135
    v_mov_b32 v9, v40
    v_mov_b32 v10, v40
    s_nop 1
    v_permlane32_swap_b32 v9, v10
    s_nop 1
    v_rcp_f32 v10, v10
    s_nop 0
    v_mul_f32 v32, v32, v10
    v_mul_f32 v33, v33, v10
    v_mul_f32 v34, v34, v10
    v_mul_f32 v35, v35, v10
    v_mul_f32 v36, v36, v10
    v_mul_f32 v37, v37, v10
    v_mul_f32 v38, v38, v10
    v_mul_f32 v39, v39, v10
    v_mul_f32 v40, v40, v10
    v_mul_f32 v41, v41, v10
    v_mul_f32 v42, v42, v10
    v_mul_f32 v43, v43, v10
    v_cvt_pk_bf16_f32 v136, v32, v33
    v_cvt_pk_bf16_f32 v137, v34, v35
    v_cvt_pk_bf16_f32 v138, v36, v37
    v_cvt_pk_bf16_f32 v139, v38, v39
    v_cvt_pk_bf16_f32 v140, v40, v41
    v_cvt_pk_bf16_f32 v141, v42, v43
    buffer_store_dwordx2 v[136:137], v224, s[16:19], s7 offen sc1
    buffer_store_dwordx2 v[138:139], v225, s[16:19], s7 offen sc1
    buffer_store_dwordx2 v[140:141], v226, s[16:19], s7 offen sc1
    s_add_u32 s7, s7, 40960
    buffer_load_dwordx4 v[80:83], v221, s[20:23], s6 offen
    buffer_load_dwordx4 v[84:87], v222, s[20:23], s6 offen
    buffer_load_dwordx4 v[88:91], v223, s[20:23], s6 offen
    s_add_u32 s42, s56, 4096
    s_add_u32 s43, s56, 8192
    s_mov_b32 s41, s56
    buffer_load_dwordx4 v[112:115], v1, s[16:19], s41 offen offset:0 sc1
    buffer_load_dwordx4 v[116:119], v1, s[16:19], s41 offen offset:1024 sc1
    buffer_load_dwordx4 v[120:123], v1, s[16:19], s41 offen offset:2048 sc1
    buffer_load_dwordx4 v[124:127], v1, s[16:19], s41 offen offset:3072 sc1
    buffer_load_dwordx4 v[128:131], v1, s[16:19], s42 offen offset:0 sc1
    buffer_load_dwordx4 v[132:135], v1, s[16:19], s42 offen offset:1024 sc1
    buffer_load_dwordx4 v[136:139], v1, s[16:19], s42 offen offset:2048 sc1
    buffer_load_dwordx4 v[140:143], v1, s[16:19], s42 offen offset:3072 sc1
    buffer_load_dwordx4 v[144:147], v1, s[16:19], s43 offen offset:0 sc1
    buffer_load_dwordx4 v[148:151], v1, s[16:19], s43 offen offset:1024 sc1
    s_mov_b32 s33, 0
K2_CK0:
    s_waitcnt vmcnt(9)
    v_max_u32 v9, v112, v113
    v_max3_u32 v9, v114, v115, v9
    v_cmp_eq_u32 vcc, -1, v9
    s_cbranch_vccnz K2_RT0
K2_OK0:
    v_mfma_f32_32x32x16_bf16 a[0:15], a[80:83], v[112:115], a[0:15]
    v_mfma_f32_32x32x16_bf16 a[16:31], a[84:87], v[112:115], a[16:31]
    v_mfma_f32_32x32x16_bf16 a[32:47], a[88:91], v[112:115], a[32:47]
    v_mfma_f32_32x32x16_bf16 a[48:63], a[92:95], v[112:115], a[48:63]
    v_mfma_f32_32x32x16_bf16 a[64:79], a[96:99], v[112:115], a[64:79]
K2_CK1:
    s_waitcnt vmcnt(8)
    v_max_u32 v9, v116, v117
    v_max3_u32 v9, v118, v119, v9
    v_cmp_eq_u32 vcc, -1, v9
    s_cbranch_vccnz K2_RT1
K2_OK1:
    v_mfma_f32_32x32x16_bf16 a[0:15], a[100:103], v[116:119], a[0:15]
    v_mfma_f32_32x32x16_bf16 a[16:31], a[104:107], v[116:119], a[16:31]
    v_mfma_f32_32x32x16_bf16 a[32:47], a[108:111], v[116:119], a[32:47]
    v_mfma_f32_32x32x16_bf16 a[48:63], a[112:115], v[116:119], a[48:63]
    v_mfma_f32_32x32x16_bf16 a[64:79], a[116:119], v[116:119], a[64:79]
K2_CK2:
    s_waitcnt vmcnt(7)
    v_max_u32 v9, v120, v121
    v_max3_u32 v9, v122, v123, v9
    v_cmp_eq_u32 vcc, -1, v9
    s_cbranch_vccnz K2_RT2
K2_OK2:
    v_mfma_f32_32x32x16_bf16 a[0:15], a[120:123], v[120:123], a[0:15]
    v_mfma_f32_32x32x16_bf16 a[16:31], a[124:127], v[120:123], a[16:31]
    v_mfma_f32_32x32x16_bf16 a[32:47], a[128:131], v[120:123], a[32:47]
    v_mfma_f32_32x32x16_bf16 a[48:63], a[132:135], v[120:123], a[48:63]
    v_mfma_f32_32x32x16_bf16 a[64:79], a[136:139], v[120:123], a[64:79]
K2_CK3:
    s_waitcnt vmcnt(6)
    v_max_u32 v9, v124, v125
    v_max3_u32 v9, v126, v127, v9
    v_cmp_eq_u32 vcc, -1, v9
    s_cbranch_vccnz K2_RT3
K2_OK3:
    v_mfma_f32_32x32x16_bf16 a[0:15], a[140:143], v[124:127], a[0:15]
    v_mfma_f32_32x32x16_bf16 a[16:31], a[144:147], v[124:127], a[16:31]
    v_mfma_f32_32x32x16_bf16 a[32:47], a[148:151], v[124:127], a[32:47]
    v_mfma_f32_32x32x16_bf16 a[48:63], a[152:155], v[124:127], a[48:63]
    v_mfma_f32_32x32x16_bf16 a[64:79], a[156:159], v[124:127], a[64:79]
K2_CK4:
    s_waitcnt vmcnt(5)
    v_max_u32 v9, v128, v129
    v_max3_u32 v9, v130, v131, v9
    v_cmp_eq_u32 vcc, -1, v9
    s_cbranch_vccnz K2_RT4
K2_OK4:
    v_mfma_f32_32x32x16_bf16 a[0:15], a[160:163], v[128:131], a[0:15]
    v_mfma_f32_32x32x16_bf16 a[16:31], a[164:167], v[128:131], a[16:31]
    v_mfma_f32_32x32x16_bf16 a[32:47], a[168:171], v[128:131], a[32:47]
    v_mfma_f32_32x32x16_bf16 a[48:63], a[172:175], v[128:131], a[48:63]
    v_mfma_f32_32x32x16_bf16 a[64:79], a[176:179], v[128:131], a[64:79]
K2_CK5:
    s_waitcnt vmcnt(4)
    v_max_u32 v9, v132, v133
    v_max3_u32 v9, v134, v135, v9
    v_cmp_eq_u32 vcc, -1, v9
    s_cbranch_vccnz K2_RT5
K2_OK5:
    v_mfma_f32_32x32x16_bf16 a[0:15], a[180:183], v[132:135], a[0:15]
    v_mfma_f32_32x32x16_bf16 a[16:31], a[184:187], v[132:135], a[16:31]
    v_mfma_f32_32x32x16_bf16 a[32:47], a[188:191], v[132:135], a[32:47]
    v_mfma_f32_32x32x16_bf16 a[48:63], a[192:195], v[132:135], a[48:63]
    v_mfma_f32_32x32x16_bf16 a[64:79], a[196:199], v[132:135], a[64:79]
K2_CK6:
    s_waitcnt vmcnt(3)
    v_max_u32 v9, v136, v137
    v_max3_u32 v9, v138, v139, v9
    v_cmp_eq_u32 vcc, -1, v9
    s_cbranch_vccnz K2_RT6
K2_OK6:
    v_mfma_f32_32x32x16_bf16 a[0:15], a[200:203], v[136:139], a[0:15]
    v_mfma_f32_32x32x16_bf16 a[16:31], a[204:207], v[136:139], a[16:31]
    v_mfma_f32_32x32x16_bf16 a[32:47], a[208:211], v[136:139], a[32:47]
    v_mfma_f32_32x32x16_bf16 a[48:63], a[212:215], v[136:139], a[48:63]
    v_mfma_f32_32x32x16_bf16 a[64:79], a[216:219], v[136:139], a[64:79]
K2_CK7:
    s_waitcnt vmcnt(2)
    v_max_u32 v9, v140, v141
    v_max3_u32 v9, v142, v143, v9
    v_cmp_eq_u32 vcc, -1, v9
    s_cbranch_vccnz K2_RT7
K2_OK7:
    v_mfma_f32_32x32x16_bf16 a[0:15], a[220:223], v[140:143], a[0:15]
    v_mfma_f32_32x32x16_bf16 a[16:31], a[224:227], v[140:143], a[16:31]
    v_mfma_f32_32x32x16_bf16 a[32:47], a[228:231], v[140:143], a[32:47]
    v_mfma_f32_32x32x16_bf16 a[48:63], a[232:235], v[140:143], a[48:63]
    v_mfma_f32_32x32x16_bf16 a[64:79], a[236:239], v[140:143], a[64:79]
K2_CK8:
    s_waitcnt vmcnt(1)
    v_max_u32 v9, v144, v145
    v_max3_u32 v9, v146, v147, v9
    v_cmp_eq_u32 vcc, -1, v9
    s_cbranch_vccnz K2_RT8
K2_OK8:
    v_mfma_f32_32x32x16_bf16 a[0:15], a[240:243], v[144:147], a[0:15]
    v_mfma_f32_32x32x16_bf16 a[16:31], a[244:247], v[144:147], a[16:31]
    v_mfma_f32_32x32x16_bf16 a[32:47], a[248:251], v[144:147], a[32:47]
    v_mfma_f32_32x32x16_bf16 a[48:63], a[252:255], v[144:147], a[48:63]
    v_mfma_f32_32x32x16_bf16 a[64:79], v[152:155], v[144:147], a[64:79]
K2_CK9:
    s_waitcnt vmcnt(0)
    v_max_u32 v9, v148, v149
    v_max3_u32 v9, v150, v151, v9
    v_cmp_eq_u32 vcc, -1, v9
    s_cbranch_vccnz K2_RT9
K2_OK9:
    v_mfma_f32_32x32x16_bf16 a[0:15], v[156:159], v[148:151], a[0:15]
    v_mfma_f32_32x32x16_bf16 a[16:31], v[160:163], v[148:151], a[16:31]
    v_mfma_f32_32x32x16_bf16 a[32:47], v[164:167], v[148:151], a[32:47]
    v_mfma_f32_32x32x16_bf16 a[48:63], v[168:171], v[148:151], a[48:63]
    v_mfma_f32_32x32x16_bf16 a[64:79], v[172:175], v[148:151], a[64:79]
    s_nop 7
    ds_write_b128 v227, a[0:3] offset:0
    ds_write_b128 v227, a[4:7] offset:32
    ds_write_b128 v227, a[8:11] offset:64
    ds_write_b128 v227, a[12:15] offset:96
    ds_write_b128 v227, a[16:19] offset:128
    ds_write_b128 v227, a[20:23] offset:160
    ds_write_b128 v227, a[24:27] offset:192
    ds_write_b128 v227, a[28:31] offset:224
    ds_write_b128 v227, a[32:35] offset:256
    ds_write_b128 v227, a[36:39] offset:288
    ds_write_b128 v227, a[40:43] offset:320
    ds_write_b128 v227, a[44:47] offset:352
    ds_write_b128 v227, a[48:51] offset:384
    ds_write_b128 v227, a[52:55] offset:416
    ds_write_b128 v227, a[56:59] offset:448
    ds_write_b128 v227, a[60:63] offset:480
    ds_write_b128 v227, a[64:67] offset:512
    ds_write_b128 v227, a[68:71] offset:544
    ds_write_b128 v227, a[72:75] offset:576
    ds_write_b128 v227, a[76:79] offset:608
    s_waitcnt lgkmcnt(0)
    s_barrier
    ds_read_b128 v[16:19], v218 offset:0
    ds_read_b128 v[20:23], v218 offset:16
    ds_read_b128 v[24:27], v218 offset:20992
    ds_read_b128 v[28:31], v218 offset:21008
    ds_read_b128 v[32:35], v218 offset:41984
    ds_read_b128 v[36:39], v218 offset:42000
    ds_read_b128 v[40:43], v218 offset:62976
    ds_read_b128 v[44:47], v218 offset:62992
    ds_read_b128 v[48:51], v219 offset:0
    ds_read_b128 v[52:55], v219 offset:16
    ds_read_b128 v[56:59], v219 offset:20992
    ds_read_b128 v[60:63], v219 offset:21008
    ds_read_b128 v[64:67], v219 offset:41984
    ds_read_b128 v[68:71], v219 offset:42000
    ds_read_b128 v[72:75], v219 offset:62976
    ds_read_b128 v[76:79], v219 offset:62992
    ds_read_b128 v[112:115], v220 offset:0
    ds_read_b128 v[116:119], v220 offset:16
    ds_read_b128 v[120:123], v220 offset:20992
    ds_read_b128 v[124:127], v220 offset:21008
    ds_read_b128 v[128:131], v220 offset:41984
    ds_read_b128 v[132:135], v220 offset:42000
    ds_read_b128 v[136:139], v220 offset:62976
    ds_read_b128 v[140:143], v220 offset:62992
    s_waitcnt lgkmcnt(15)
    v_add_f32 v16, v16, v24
    v_add_f32 v32, v32, v40
    v_add_f32 v16, v16, v32
    v_add_f32 v17, v17, v25
    v_add_f32 v33, v33, v41
    v_add_f32 v17, v17, v33
    v_add_f32 v18, v18, v26
    v_add_f32 v34, v34, v42
    v_add_f32 v18, v18, v34
    v_add_f32 v19, v19, v27
    v_add_f32 v35, v35, v43
    v_add_f32 v19, v19, v35
    v_add_f32 v20, v20, v28
    v_add_f32 v36, v36, v44
    v_add_f32 v20, v20, v36
    v_add_f32 v21, v21, v29
    v_add_f32 v37, v37, v45
    v_add_f32 v21, v21, v37
    v_add_f32 v22, v22, v30
    v_add_f32 v38, v38, v46
    v_add_f32 v22, v22, v38
    v_add_f32 v23, v23, v31
    v_add_f32 v39, v39, v47
    v_add_f32 v23, v23, v39
    v_lshlrev_b32 v9, 16, v80
    v_and_b32 v10, 0xffff0000, v80
    v_add_f32 v9, v9, v16
    v_add_f32 v10, v10, v17
    v_cvt_pk_bf16_f32 v32, v9, v10
    v_lshlrev_b32 v9, 16, v81
    v_and_b32 v10, 0xffff0000, v81
    v_add_f32 v9, v9, v18
    v_add_f32 v10, v10, v19
    v_cvt_pk_bf16_f32 v33, v9, v10
    v_lshlrev_b32 v9, 16, v82
    v_and_b32 v10, 0xffff0000, v82
    v_add_f32 v9, v9, v20
    v_add_f32 v10, v10, v21
    v_cvt_pk_bf16_f32 v34, v9, v10
    v_lshlrev_b32 v9, 16, v83
    v_and_b32 v10, 0xffff0000, v83
    v_add_f32 v9, v9, v22
    v_add_f32 v10, v10, v23
    v_cvt_pk_bf16_f32 v35, v9, v10
    buffer_store_dwordx4 v[32:35], v221, s[8:11], s6 offen
    s_waitcnt lgkmcnt(8)
    v_add_f32 v48, v48, v56
    v_add_f32 v64, v64, v72
    v_add_f32 v48, v48, v64
    v_add_f32 v49, v49, v57
    v_add_f32 v65, v65, v73
    v_add_f32 v49, v49, v65
    v_add_f32 v50, v50, v58
    v_add_f32 v66, v66, v74
    v_add_f32 v50, v50, v66
    v_add_f32 v51, v51, v59
    v_add_f32 v67, v67, v75
    v_add_f32 v51, v51, v67
    v_add_f32 v52, v52, v60
    v_add_f32 v68, v68, v76
    v_add_f32 v52, v52, v68
    v_add_f32 v53, v53, v61
    v_add_f32 v69, v69, v77
    v_add_f32 v53, v53, v69
    v_add_f32 v54, v54, v62
    v_add_f32 v70, v70, v78
    v_add_f32 v54, v54, v70
    v_add_f32 v55, v55, v63
    v_add_f32 v71, v71, v79
    v_add_f32 v55, v55, v71
    v_lshlrev_b32 v9, 16, v84
    v_and_b32 v10, 0xffff0000, v84
    v_add_f32 v9, v9, v48
    v_add_f32 v10, v10, v49
    v_cvt_pk_bf16_f32 v64, v9, v10
    v_lshlrev_b32 v9, 16, v85
    v_and_b32 v10, 0xffff0000, v85
    v_add_f32 v9, v9, v50
    v_add_f32 v10, v10, v51
    v_cvt_pk_bf16_f32 v65, v9, v10
    v_lshlrev_b32 v9, 16, v86
    v_and_b32 v10, 0xffff0000, v86
    v_add_f32 v9, v9, v52
    v_add_f32 v10, v10, v53
    v_cvt_pk_bf16_f32 v66, v9, v10
    v_lshlrev_b32 v9, 16, v87
    v_and_b32 v10, 0xffff0000, v87
    v_add_f32 v9, v9, v54
    v_add_f32 v10, v10, v55
    v_cvt_pk_bf16_f32 v67, v9, v10
    buffer_store_dwordx4 v[64:67], v222, s[8:11], s6 offen
    s_waitcnt lgkmcnt(0)
    v_add_f32 v112, v112, v120
    v_add_f32 v128, v128, v136
    v_add_f32 v112, v112, v128
    v_add_f32 v113, v113, v121
    v_add_f32 v129, v129, v137
    v_add_f32 v113, v113, v129
    v_add_f32 v114, v114, v122
    v_add_f32 v130, v130, v138
    v_add_f32 v114, v114, v130
    v_add_f32 v115, v115, v123
    v_add_f32 v131, v131, v139
    v_add_f32 v115, v115, v131
    v_add_f32 v116, v116, v124
    v_add_f32 v132, v132, v140
    v_add_f32 v116, v116, v132
    v_add_f32 v117, v117, v125
    v_add_f32 v133, v133, v141
    v_add_f32 v117, v117, v133
    v_add_f32 v118, v118, v126
    v_add_f32 v134, v134, v142
    v_add_f32 v118, v118, v134
    v_add_f32 v119, v119, v127
    v_add_f32 v135, v135, v143
    v_add_f32 v119, v119, v135
    v_lshlrev_b32 v9, 16, v88
    v_and_b32 v10, 0xffff0000, v88
    v_add_f32 v9, v9, v112
    v_add_f32 v10, v10, v113
    v_cvt_pk_bf16_f32 v128, v9, v10
    v_lshlrev_b32 v9, 16, v89
    v_and_b32 v10, 0xffff0000, v89
    v_add_f32 v9, v9, v114
    v_add_f32 v10, v10, v115
    v_cvt_pk_bf16_f32 v129, v9, v10
    v_lshlrev_b32 v9, 16, v90
    v_and_b32 v10, 0xffff0000, v90
    v_add_f32 v9, v9, v116
    v_add_f32 v10, v10, v117
    v_cvt_pk_bf16_f32 v130, v9, v10
    v_lshlrev_b32 v9, 16, v91
    v_and_b32 v10, 0xffff0000, v91
    v_add_f32 v9, v9, v118
    v_add_f32 v10, v10, v119
    v_cvt_pk_bf16_f32 v131, v9, v10
    buffer_store_dwordx4 v[128:131], v223, s[8:11], s6 offen
    s_endpgm
K2_RT0:
    s_add_u32 s33, s33, 1
    s_cmp_ge_u32 s33, 0x20000
    s_cbranch_scc1 K2_OK0
    buffer_load_dwordx4 v[112:115], v1, s[16:19], s41 offen offset:0 sc1
    buffer_load_dwordx4 v[116:119], v1, s[16:19], s41 offen offset:1024 sc1
    buffer_load_dwordx4 v[120:123], v1, s[16:19], s41 offen offset:2048 sc1
    buffer_load_dwordx4 v[124:127], v1, s[16:19], s41 offen offset:3072 sc1
    buffer_load_dwordx4 v[128:131], v1, s[16:19], s42 offen offset:0 sc1
    buffer_load_dwordx4 v[132:135], v1, s[16:19], s42 offen offset:1024 sc1
    buffer_load_dwordx4 v[136:139], v1, s[16:19], s42 offen offset:2048 sc1
    buffer_load_dwordx4 v[140:143], v1, s[16:19], s42 offen offset:3072 sc1
    buffer_load_dwordx4 v[144:147], v1, s[16:19], s43 offen offset:0 sc1
    buffer_load_dwordx4 v[148:151], v1, s[16:19], s43 offen offset:1024 sc1
    s_branch K2_CK0
K2_RT1:
    s_add_u32 s33, s33, 1
    s_cmp_ge_u32 s33, 0x20000
    s_cbranch_scc1 K2_OK1
    buffer_load_dwordx4 v[116:119], v1, s[16:19], s41 offen offset:1024 sc1
    buffer_load_dwordx4 v[120:123], v1, s[16:19], s41 offen offset:2048 sc1
    buffer_load_dwordx4 v[124:127], v1, s[16:19], s41 offen offset:3072 sc1
    buffer_load_dwordx4 v[128:131], v1, s[16:19], s42 offen offset:0 sc1
    buffer_load_dwordx4 v[132:135], v1, s[16:19], s42 offen offset:1024 sc1
    buffer_load_dwordx4 v[136:139], v1, s[16:19], s42 offen offset:2048 sc1
    buffer_load_dwordx4 v[140:143], v1, s[16:19], s42 offen offset:3072 sc1
    buffer_load_dwordx4 v[144:147], v1, s[16:19], s43 offen offset:0 sc1
    buffer_load_dwordx4 v[148:151], v1, s[16:19], s43 offen offset:1024 sc1
    s_branch K2_CK1
K2_RT2:
    s_add_u32 s33, s33, 1
    s_cmp_ge_u32 s33, 0x20000
    s_cbranch_scc1 K2_OK2
    buffer_load_dwordx4 v[120:123], v1, s[16:19], s41 offen offset:2048 sc1
    buffer_load_dwordx4 v[124:127], v1, s[16:19], s41 offen offset:3072 sc1
    buffer_load_dwordx4 v[128:131], v1, s[16:19], s42 offen offset:0 sc1
    buffer_load_dwordx4 v[132:135], v1, s[16:19], s42 offen offset:1024 sc1
    buffer_load_dwordx4 v[136:139], v1, s[16:19], s42 offen offset:2048 sc1
    buffer_load_dwordx4 v[140:143], v1, s[16:19], s42 offen offset:3072 sc1
    buffer_load_dwordx4 v[144:147], v1, s[16:19], s43 offen offset:0 sc1
    buffer_load_dwordx4 v[148:151], v1, s[16:19], s43 offen offset:1024 sc1
    s_branch K2_CK2
K2_RT3:
    s_add_u32 s33, s33, 1
    s_cmp_ge_u32 s33, 0x20000
    s_cbranch_scc1 K2_OK3
    buffer_load_dwordx4 v[124:127], v1, s[16:19], s41 offen offset:3072 sc1
    buffer_load_dwordx4 v[128:131], v1, s[16:19], s42 offen offset:0 sc1
    buffer_load_dwordx4 v[132:135], v1, s[16:19], s42 offen offset:1024 sc1
    buffer_load_dwordx4 v[136:139], v1, s[16:19], s42 offen offset:2048 sc1
    buffer_load_dwordx4 v[140:143], v1, s[16:19], s42 offen offset:3072 sc1
    buffer_load_dwordx4 v[144:147], v1, s[16:19], s43 offen offset:0 sc1
    buffer_load_dwordx4 v[148:151], v1, s[16:19], s43 offen offset:1024 sc1
    s_branch K2_CK3
K2_RT4:
    s_add_u32 s33, s33, 1
    s_cmp_ge_u32 s33, 0x20000
    s_cbranch_scc1 K2_OK4
    buffer_load_dwordx4 v[128:131], v1, s[16:19], s42 offen offset:0 sc1
    buffer_load_dwordx4 v[132:135], v1, s[16:19], s42 offen offset:1024 sc1
    buffer_load_dwordx4 v[136:139], v1, s[16:19], s42 offen offset:2048 sc1
    buffer_load_dwordx4 v[140:143], v1, s[16:19], s42 offen offset:3072 sc1
    buffer_load_dwordx4 v[144:147], v1, s[16:19], s43 offen offset:0 sc1
    buffer_load_dwordx4 v[148:151], v1, s[16:19], s43 offen offset:1024 sc1
    s_branch K2_CK4
K2_RT5:
    s_add_u32 s33, s33, 1
    s_cmp_ge_u32 s33, 0x20000
    s_cbranch_scc1 K2_OK5
    buffer_load_dwordx4 v[132:135], v1, s[16:19], s42 offen offset:1024 sc1
    buffer_load_dwordx4 v[136:139], v1, s[16:19], s42 offen offset:2048 sc1
    buffer_load_dwordx4 v[140:143], v1, s[16:19], s42 offen offset:3072 sc1
    buffer_load_dwordx4 v[144:147], v1, s[16:19], s43 offen offset:0 sc1
    buffer_load_dwordx4 v[148:151], v1, s[16:19], s43 offen offset:1024 sc1
    s_branch K2_CK5
K2_RT6:
    s_add_u32 s33, s33, 1
    s_cmp_ge_u32 s33, 0x20000
    s_cbranch_scc1 K2_OK6
    buffer_load_dwordx4 v[136:139], v1, s[16:19], s42 offen offset:2048 sc1
    buffer_load_dwordx4 v[140:143], v1, s[16:19], s42 offen offset:3072 sc1
    buffer_load_dwordx4 v[144:147], v1, s[16:19], s43 offen offset:0 sc1
    buffer_load_dwordx4 v[148:151], v1, s[16:19], s43 offen offset:1024 sc1
    s_branch K2_CK6
K2_RT7:
    s_add_u32 s33, s33, 1
    s_cmp_ge_u32 s33, 0x20000
    s_cbranch_scc1 K2_OK7
    buffer_load_dwordx4 v[140:143], v1, s[16:19], s42 offen offset:3072 sc1
    buffer_load_dwordx4 v[144:147], v1, s[16:19], s43 offen offset:0 sc1
    buffer_load_dwordx4 v[148:151], v1, s[16:19], s43 offen offset:1024 sc1
    s_branch K2_CK7
K2_RT8:
    s_add_u32 s33, s33, 1
    s_cmp_ge_u32 s33, 0x20000
    s_cbranch_scc1 K2_OK8
    buffer_load_dwordx4 v[144:147], v1, s[16:19], s43 offen offset:0 sc1
    buffer_load_dwordx4 v[148:151], v1, s[16:19], s43 offen offset:1024 sc1
    s_branch K2_CK8
K2_RT9:
    s_add_u32 s33, s33, 1
    s_cmp_ge_u32 s33, 0x20000
    s_cbranch_scc1 K2_OK9
    buffer_load_dwordx4 v[148:151], v1, s[16:19], s43 offen offset:1024 sc1
    s_branch K2_CK9
K2_SLOW:
    s_waitcnt vmcnt(0)
    v_mov_b32 v86, 0
    v_mov_b32 v4, 0xff800000
    v_mov_b32 v94, 0
    v_mov_b32 v5, 0xff800000
    v_mov_b32 v102, 0
    v_mov_b32 v6, 0xff800000
    v_mov_b32 v110, 0
    v_mov_b32 v7, 0xff800000
    v_cmp_gt_u32 vcc, 32, v0
    s_nop 1
    v_cndmask_b32 v84, 0, v84, vcc
    v_cndmask_b32 v85, 0, v85, vcc
    v_cndmask_b32 v92, 0, v92, vcc
    v_cndmask_b32 v93, 0, v93, vcc
    v_cndmask_b32 v100, 0, v100, vcc
    v_cndmask_b32 v101, 0, v101, vcc
    v_cndmask_b32 v108, 0, v108, vcc
    v_cndmask_b32 v109, 0, v109, vcc
    s_mov_b32 s33, 0
K2_SL:
    buffer_load_dwordx4 v[200:203], v1, s[12:15], s40 offen
    buffer_load_dwordx2 v[204:205], v2, s[12:15], s40 offen
    s_add_u32 s40, s40, 2624
    s_waitcnt vmcnt(0)
    v_mfma_f32_32x32x16_bf16 v[112:127], v[200:203], v[80:83], 0
    v_mfma_f32_32x32x16_bf16 v[112:127], v[204:207], v[84:87], v[112:127]
    s_nop 7
    s_nop 7
    s_nop 3
    v_max_f32 v4, v4, v112
    v_max_f32 v4, v4, v113
    v_max_f32 v4, v4, v114
    v_max_f32 v4, v4, v115
    v_max_f32 v4, v4, v116
    v_max_f32 v4, v4, v117
    v_max_f32 v4, v4, v118
    v_max_f32 v4, v4, v119
    v_max_f32 v4, v4, v120
    v_max_f32 v4, v4, v121
    v_max_f32 v4, v4, v122
    v_max_f32 v4, v4, v123
    v_max_f32 v4, v4, v124
    v_max_f32 v4, v4, v125
    v_max_f32 v4, v4, v126
    v_max_f32 v4, v4, v127
    s_nop 1
    v_mfma_f32_32x32x16_bf16 v[112:127], v[200:203], v[88:91], 0
    v_mfma_f32_32x32x16_bf16 v[112:127], v[204:207], v[92:95], v[112:127]
    s_nop 7
    s_nop 7
    s_nop 3
    v_max_f32 v5, v5, v112
    v_max_f32 v5, v5, v113
    v_max_f32 v5, v5, v114
    v_max_f32 v5, v5, v115
    v_max_f32 v5, v5, v116
    v_max_f32 v5, v5, v117
    v_max_f32 v5, v5, v118
    v_max_f32 v5, v5, v119
    v_max_f32 v5, v5, v120
    v_max_f32 v5, v5, v121
    v_max_f32 v5, v5, v122
    v_max_f32 v5, v5, v123
    v_max_f32 v5, v5, v124
    v_max_f32 v5, v5, v125
    v_max_f32 v5, v5, v126
    v_max_f32 v5, v5, v127
    s_nop 1
    v_mfma_f32_32x32x16_bf16 v[112:127], v[200:203], v[96:99], 0
    v_mfma_f32_32x32x16_bf16 v[112:127], v[204:207], v[100:103], v[112:127]
    s_nop 7
    s_nop 7
    s_nop 3
    v_max_f32 v6, v6, v112
    v_max_f32 v6, v6, v113
    v_max_f32 v6, v6, v114
    v_max_f32 v6, v6, v115
    v_max_f32 v6, v6, v116
    v_max_f32 v6, v6, v117
    v_max_f32 v6, v6, v118
    v_max_f32 v6, v6, v119
    v_max_f32 v6, v6, v120
    v_max_f32 v6, v6, v121
    v_max_f32 v6, v6, v122
    v_max_f32 v6, v6, v123
    v_max_f32 v6, v6, v124
    v_max_f32 v6, v6, v125
    v_max_f32 v6, v6, v126
    v_max_f32 v6, v6, v127
    s_nop 1
    v_mfma_f32_32x32x16_bf16 v[112:127], v[200:203], v[104:107], 0
    v_mfma_f32_32x32x16_bf16 v[112:127], v[204:207], v[108:111], v[112:127]
    s_nop 7
    s_nop 7
    s_nop 3
    v_max_f32 v7, v7, v112
    v_max_f32 v7, v7, v113
    v_max_f32 v7, v7, v114
    v_max_f32 v7, v7, v115
    v_max_f32 v7, v7, v116
    v_max_f32 v7, v7, v117
    v_max_f32 v7, v7, v118
    v_max_f32 v7, v7, v119
    v_max_f32 v7, v7, v120
    v_max_f32 v7, v7, v121
    v_max_f32 v7, v7, v122
    v_max_f32 v7, v7, v123
    v_max_f32 v7, v7, v124
    v_max_f32 v7, v7, v125
    v_max_f32 v7, v7, v126
    v_max_f32 v7, v7, v127
    s_nop 1
    s_add_u32 s33, s33, 1
    s_cmp_lt_u32 s33, 64
    s_cbranch_scc1 K2_SL
    v_mov_b32 v8, v4
    s_nop 1
    v_permlane32_swap_b32 v8, v4
    s_nop 1
    v_max_f32 v8, v8, v4
    v_sub_f32 v8, 0, v8
    v_cvt_pk_bf16_f32 v9, v8, 0
    v_lshlrev_b32 v4, 16, v9
    v_sub_f32 v8, v8, v4
    v_cvt_pk_bf16_f32 v87, v8, 0
    v_lshlrev_b32 v4, 16, v87
    v_sub_f32 v8, v8, v4
    v_or_b32 v86, v9, v4
    v_cvt_pk_bf16_f32 v87, v8, 0
    v_mov_b32 v8, v5
    s_nop 1
    v_permlane32_swap_b32 v8, v5
    s_nop 1
    v_max_f32 v8, v8, v5
    v_sub_f32 v8, 0, v8
    v_cvt_pk_bf16_f32 v9, v8, 0
    v_lshlrev_b32 v5, 16, v9
    v_sub_f32 v8, v8, v5
    v_cvt_pk_bf16_f32 v95, v8, 0
    v_lshlrev_b32 v5, 16, v95
    v_sub_f32 v8, v8, v5
    v_or_b32 v94, v9, v5
    v_cvt_pk_bf16_f32 v95, v8, 0
    v_mov_b32 v8, v6
    s_nop 1
    v_permlane32_swap_b32 v8, v6
    s_nop 1
    v_max_f32 v8, v8, v6
    v_sub_f32 v8, 0, v8
    v_cvt_pk_bf16_f32 v9, v8, 0
    v_lshlrev_b32 v6, 16, v9
    v_sub_f32 v8, v8, v6
    v_cvt_pk_bf16_f32 v103, v8, 0
    v_lshlrev_b32 v6, 16, v103
    v_sub_f32 v8, v8, v6
    v_or_b32 v102, v9, v6
    v_cvt_pk_bf16_f32 v103, v8, 0
    v_mov_b32 v8, v7
    s_nop 1
    v_permlane32_swap_b32 v8, v7
    s_nop 1
    v_max_f32 v8, v8, v7
    v_sub_f32 v8, 0, v8
    v_cvt_pk_bf16_f32 v9, v8, 0
    v_lshlrev_b32 v7, 16, v9
    v_sub_f32 v8, v8, v7
    v_cvt_pk_bf16_f32 v111, v8, 0
    v_lshlrev_b32 v7, 16, v111
    v_sub_f32 v8, v8, v7
    v_or_b32 v110, v9, v7
    v_cvt_pk_bf16_f32 v111, v8, 0
    s_branch K2_RUN
K2_END:
    s_endpgm
.section .rodata,"a"
.p2align 6
.amdhsa_kernel mha_k1_kernel
  .amdhsa_next_free_vgpr 256
  .amdhsa_next_free_sgpr 102
  .amdhsa_accum_offset 256
  .amdhsa_group_segment_fixed_size 0
  .amdhsa_kernarg_size 80
  .amdhsa_user_sgpr_count 2
  .amdhsa_user_sgpr_kernarg_segment_ptr 1
  .amdhsa_system_sgpr_workgroup_id_x 1
.end_amdhsa_kernel
.p2align 6
.amdhsa_kernel mha_k2_kernel
  .amdhsa_next_free_vgpr 488
  .amdhsa_next_free_sgpr 102
  .amdhsa_accum_offset 232
  .amdhsa_group_segment_fixed_size 0
  .amdhsa_kernarg_size 80
  .amdhsa_user_sgpr_count 2
  .amdhsa_user_sgpr_kernarg_segment_ptr 1
  .amdhsa_system_sgpr_workgroup_id_x 1
.end_amdhsa_kernel
```
